```python
import torch

def _softmax(x, axis=-1):
    return torch.softmax(x, dim=axis)
def _gelu(x):
    return torch.nn.functional.gelu(x, approximate="tanh")
def _silu(x):
    return torch.nn.functional.silu(x)
def _sigmoid(x):
    return torch.sigmoid(x)
def _layernorm(x, axis=-1, eps=1e-5):
    m = x.mean(dim=axis, keepdim=True)
    v = x.var(dim=axis, keepdim=True, unbiased=False)
    return (x - m) / torch.sqrt(v + eps)
def _scatter_add(tgt, idx, src, axis=0):
    return tgt.clone().index_add_(axis, idx, src)
def _segment_sum(src, seg, n):
    out = torch.zeros((n,) + src.shape[1:], dtype=src.dtype)
    return out.index_add_(0, seg, src)
def _pad(x, pw):
    flat = tuple(v for pair in reversed(pw) for v in pair)
    return torch.nn.functional.pad(x, flat)

kernel_name = 'concat_heads__sliding_local_dilated__spectral_fnet__prompt'

def setup_inputs():

    _w = (lambda a: (lambda t: t.to(torch.bfloat16) if t.is_floating_point() else t)(torch.as_tensor(a)))
    def _A_setup():
        B, S, D = 1, 2048, 512
        return {
            "x": _w((lambda *s: torch.randn(*s, dtype=torch.bfloat16) * 0.2)(B, S, D)),
            "wqkv": _w((lambda *s: torch.randn(*s, dtype=torch.bfloat16) * 0.8)(D, 3 * D)),
            "wo": _w((lambda *s: torch.randn(*s, dtype=torch.bfloat16) * 0.2)(D, D)),
        }
    _A_in = _A_setup()

    def _B_setup():
        B, S, D = 1, 2048, 512
        ns = torch.arange(S)[:, None] * torch.arange(S)[None, :]
        nd = torch.arange(D)[:, None] * torch.arange(D)[None, :]
        Ws_re = torch.cos(-2.0 * torch.pi * ns / S).to(float)
        Ws_im = torch.sin(-2.0 * torch.pi * ns / S).to(float)
        Wd_re = torch.cos(-2.0 * torch.pi * nd / D).to(float)
        Wd_im = torch.sin(-2.0 * torch.pi * nd / D).to(float)
        return {
            "x": _w((lambda *s: torch.randn(*s, dtype=torch.bfloat16) * 0.05)(B, S, D)),
            "dft_seq_re": _w(Ws_re),
            "dft_seq_im": _w(Ws_im),
            "dft_hid_re": _w(Wd_re),
            "dft_hid_im": _w(Wd_im),
        }
    _B_in = _B_setup()

    return {
        "A_x": _A_in["x"],
        "A_wqkv": _A_in["wqkv"],
        "A_wo": _A_in["wo"],
        "B_x": _B_in["x"],
        "B_dft_seq_re": _B_in["dft_seq_re"],
        "B_dft_seq_im": _B_in["dft_seq_im"],
        "B_dft_hid_re": _B_in["dft_hid_re"],
        "B_dft_hid_im": _B_in["dft_hid_im"],
    }

def reference(A_x, A_wqkv, A_wo, B_x, B_dft_seq_re, B_dft_seq_im, B_dft_hid_re, B_dft_hid_im):
    def _A_ref(x, wqkv, wo):
        B, S, D = x.shape
        H = 32; Dh = D // H
        W, dil = 8, 2
        qkv = (lambda x, *d: x.permute(*d))((x @ wqkv).reshape(B, S, 3, H, Dh), 2, 0, 3, 1, 4)
        q, k, v = qkv[0], qkv[1], qkv[2]
        scale = Dh ** -0.5
        pos = torch.arange(S)
        off = torch.arange(W) * dil
        idx = pos[:, None] - off[None, :]
        mask = idx >= 0
        idx_c = torch.where(mask, idx, 0).reshape(-1)
        kg = k[:, :, idx_c, :].reshape(B, H, S, W, Dh)
        vg = v[:, :, idx_c, :].reshape(B, H, S, W, Dh)
        logits = torch.einsum("bhsd,bhswd->bhsw", q, kg) * scale
        logits = torch.where(mask[None, None, :, :], logits, -1e9)
        attn = _softmax(logits, axis=-1)
        o = torch.einsum("bhsw,bhswd->bhsd", attn, vg)
        return (lambda x, *d: x.permute(*d))(o, 0, 2, 1, 3).reshape(B, S, D) @ wo

    def _B_ref(x, dft_seq_re, dft_seq_im, dft_hid_re, dft_hid_im):
        a = torch.einsum("bsd,ed->bse", x, dft_hid_re)
        b = torch.einsum("bsd,ed->bse", x, dft_hid_im)
        y = torch.einsum("ts,bse->bte", dft_seq_re, a) - torch.einsum("ts,bse->bte", dft_seq_im, b)
        return y

    a = _A_ref(A_x, A_wqkv, A_wo)
    b = _B_ref(B_x, B_dft_seq_re, B_dft_seq_im, B_dft_hid_re, B_dft_hid_im)
    return torch.concatenate([a, b], axis=-1)
```

```asm
; @launch grid=(256,1,1) block=(512,1,1) lds=163840
.amdgcn_target "amdgcn-amd-amdhsa--gfx950"
.text
.globl concat_heads__sliding_local_dilated__spectral_fnet__prompt_kernel
.p2align 8
.type concat_heads__sliding_local_dilated__spectral_fnet__prompt_kernel,@function
concat_heads__sliding_local_dilated__spectral_fnet__prompt_kernel:
L_entry:
    s_load_dwordx16 s[4:19], s[0:1], 0
    s_load_dwordx4 s[20:23], s[0:1], 64
    s_load_dwordx2 s[24:25], s[0:1], 80
    s_cmp_ge_u32 s2, 256
    s_cbranch_scc1 L_end
    v_lshrrev_b32 v1, 6, v0
    v_and_b32 v0, 63, v0
    v_readfirstlane_b32 s3, v1
    s_and_b32 s26, s2, 7
    s_lshr_b32 s27, s2, 3
    v_lshrrev_b32 v1, 3, v0
    v_and_b32 v2, 7, v0
    v_lshrrev_b32 v3, 1, v1
    s_cmp_lg_u32 s3, 7
    s_cbranch_scc1 L_nocpf
    s_getpc_b64 s[62:63]
L_pc2:
    s_sub_u32 s62, s62, L_pc2-L_entry
    s_subb_u32 s63, s63, 0
    s_lshl_b32 s49, s27, 7
    v_lshl_add_u32 v6, v0, 12, s49
    v_min_u32 v6, L_end-L_entry, v6
    s_mov_b64 exec, 0x3f
    global_load_dword v248, v6, s[62:63]
    s_cmp_lg_u32 s2, 0
    s_cbranch_scc1 L_notag
    s_memrealtime s[64:65]
    s_mov_b64 exec, 1
    s_waitcnt lgkmcnt(0)
    s_bitset1_b32 s65, 30
    v_mov_b32 v30, s64
    v_mov_b32 v31, s65
    global_store_dwordx2 v0, v[30:31], s[22:23] sc1
L_notag:
    s_mov_b64 exec, -1
L_nocpf:
    s_cmp_ge_u32 s27, 8
    s_cbranch_scc1 L_A
    s_lshl_b32 s45, s26, 3
    s_add_u32 s45, s45, s27
    v_lshrrev_b32 v5, 4, v0
    v_and_b32_e64 v4, 15, v0
    v_mov_b32 v19, 65536
    s_cmp_ge_u32 s3, 4
    s_cbranch_scc1 L_Bcomp
    v_lshlrev_b32 v6, 2, v5
    v_xor_b32 v6, v6, v0
    v_lshlrev_b32 v6, 4, v6
    v_xor_b32 v7, 16, v6
    v_xor_b32 v8, 32, v6
    v_xor_b32 v9, 48, v6
    s_lshl_b32 s49, s3, 9
    s_add_u32 s49, s49, s45
    s_lshl_b32 s50, s49, 10
    s_lshl_b32 s49, s3, 13
    s_add_u32 m0, s49, 69632
    s_waitcnt lgkmcnt(0)
    s_mov_b32 s28, s10
    s_and_b32 s29, s11, 0xffff
    s_mov_b32 s30, 0x200000
    s_mov_b32 s31, 0x20000
    buffer_load_dwordx4 v6, s[28:31], s50 offen lds
    s_add_u32 s50, s50, 0x10000
    s_add_u32 m0, m0, 1024
    s_nop 0
    s_nop 0
    buffer_load_dwordx4 v7, s[28:31], s50 offen lds
    s_add_u32 s50, s50, 0x10000
    s_add_u32 m0, m0, 1024
    s_nop 0
    s_nop 0
    buffer_load_dwordx4 v8, s[28:31], s50 offen lds
    s_add_u32 s50, s50, 0x10000
    s_add_u32 m0, m0, 1024
    s_nop 0
    s_nop 0
    buffer_load_dwordx4 v9, s[28:31], s50 offen lds
    s_add_u32 s50, s50, 0x10000
    s_add_u32 m0, m0, 1024
    s_nop 0
    s_nop 0
    buffer_load_dwordx4 v6, s[28:31], s50 offen lds
    s_add_u32 s50, s50, 0x10000
    s_add_u32 m0, m0, 1024
    s_nop 0
    s_nop 0
    buffer_load_dwordx4 v7, s[28:31], s50 offen lds
    s_add_u32 s50, s50, 0x10000
    s_add_u32 m0, m0, 1024
    s_nop 0
    s_nop 0
    buffer_load_dwordx4 v8, s[28:31], s50 offen lds
    s_add_u32 s50, s50, 0x10000
    s_add_u32 m0, m0, 1024
    s_nop 0
    buffer_load_dwordx4 v9, s[28:31], s50 offen lds
    s_branch L_B
L_A:
    s_and_b32 s44, s27, 7
    s_lshr_b32 s45, s27, 3
    s_sub_u32 s45, s45, 1
    s_lshr_b32 s46, s26, 2
    s_and_b32 s47, s26, 3
    s_lshl_b32 s47, s47, 8
    s_mul_i32 s49, s45, 88
    s_add_u32 s47, s47, s49
    s_sub_u32 s47, s47, 16
    s_max_i32 s47, s47, 0
    s_cmp_ge_u32 s3, 4
    s_cbranch_scc1 L_Acons
    s_and_b32 s48, s3, 1
    s_lshl_b32 s49, s48, 2
    v_or_b32 v4, s49, v3
    v_xor_b32 v4, v4, v2
    v_lshlrev_b32 v4, 4, v4
    v_lshl_add_u32 v4, v1, 11, v4
    s_lshl_b32 s49, s3, 3
    s_add_u32 s49, s49, s47
    s_lshl_b32 s49, s49, 1
    s_add_u32 s49, s49, s46
    s_lshl_b32 s49, s49, 10
    v_add_u32 v40, s49, v4
    v_add_u32 v41, 0x10000, v40
    v_add_u32 v42, 0x20000, v40
    v_and_b32 v5, 1, v3
    s_lshl_b32 s49, s48, 1
    v_or_b32 v5, s49, v5
    v_lshlrev_b32 v5, 1, v5
    v_xor_b32 v5, v5, v2
    v_lshlrev_b32 v5, 4, v5
    s_lshl_b32 s49, s3, 3
    v_add_u32 v6, s49, v1
    v_mul_u32_u24 v6, 3072, v6
    s_lshl_b32 s49, s44, 7
    s_nop 0
    v_add3_u32 v43, v6, v5, s49
    v_add_u32 v44, 0x18000, v43
    v_add_u32 v45, 0x400, v43
    v_add_u32 v46, 0x18400, v43
    v_add_u32 v47, 0x800, v43
    v_add_u32 v48, 0x18800, v43
    s_lshl_b32 s52, s3, 10
    s_mov_b32 m0, s52
    s_mul_i32 s56, s44, 2
    s_mul_i32 s49, s45, 0
    s_add_u32 s56, s56, s49
    s_mul_i32 s49, s26, 3
    s_add_u32 s56, s56, s49
    s_and_b32 s56, s56, 7
    s_mul_i32 s57, s56, 196608
    s_lshl_b32 s56, s56, 7
    s_waitcnt lgkmcnt(0)
    s_mov_b32 s28, s4
    s_nop 0
    s_and_b32 s29, s5, 0xffff
    s_mov_b32 s30, 0x200000
    s_mov_b32 s31, 0x20000
    s_mov_b32 s32, s6
    s_nop 0
    s_and_b32 s33, s7, 0xffff
    s_mov_b32 s34, 0x180000
    s_mov_b32 s35, 0x20000
    buffer_load_dwordx4 v40, s[28:31], s56 offen lds
    s_add_u32 m0, m0, 4096
    s_nop 0
    buffer_load_dwordx4 v41, s[28:31], s56 offen lds
    s_add_u32 m0, m0, 4096
    s_nop 0
    buffer_load_dwordx4 v42, s[28:31], s56 offen lds
    s_add_u32 m0, m0, 4096
    s_nop 0
    buffer_load_dwordx4 v43, s[32:35], s57 offen lds
    s_add_u32 m0, m0, 4096
    s_nop 0
    buffer_load_dwordx4 v44, s[32:35], s57 offen lds
    s_add_u32 m0, m0, 4096
    s_nop 0
    buffer_load_dwordx4 v45, s[32:35], s57 offen lds
    s_add_u32 m0, m0, 4096
    s_nop 0
    buffer_load_dwordx4 v46, s[32:35], s57 offen lds
    s_add_u32 m0, m0, 4096
    s_nop 0
    buffer_load_dwordx4 v47, s[32:35], s57 offen lds
    s_add_u32 m0, m0, 4096
    s_nop 0
    buffer_load_dwordx4 v48, s[32:35], s57 offen lds
    v_and_b32 v8, 1, v3
    s_lshl_b32 s49, s48, 1
    v_or_b32 v8, s49, v8
    v_lshlrev_b32 v8, 1, v8
    v_xor_b32 v8, v8, v2
    v_lshlrev_b32 v8, 4, v8
    s_lshl_b32 s49, s3, 3
    v_add_u32 v9, s49, v1
    v_lshl_add_u32 v50, v9, 10, v8
    s_lshl_b32 s50, s44, 7
    v_add_u32 v50, s50, v50
    s_mul_i32 s68, s45, 5
    s_min_u32 s49, s45, 1
    s_add_u32 s68, s68, s49
    s_lshl_b32 s93, s44, 1
    s_mul_i32 s49, s45, 5
    s_add_u32 s93, s93, s49
    s_and_b32 s93, s93, 15
    s_add_u32 s68, s68, s3
    s_lshl_b32 s49, s26, 4
    s_add_u32 s49, s49, s68
    s_lshr_b32 s90, s49, 2
    s_lshl_b32 s90, s90, 8
    s_and_b32 s91, s49, 3
    s_add_u32 s90, s90, s91
    s_lshl_b32 s90, s90, 8
    s_and_b32 s91, s49, 63
    s_lshl_b32 s91, s91, 5
    s_lshr_b32 s49, s49, 6
    s_add_u32 s91, s91, s49
    s_lshl_b32 s91, s91, 11
    s_cmp_ge_u32 s68, 5
    s_cselect_b32 s58, 1, 0
    s_mov_b32 s59, s58
    s_cmp_ge_u32 s68, 11
    s_cmov_b32 s58, 2
    s_cmp_ge_u32 s68, 10
    s_cmov_b32 s59, 2
    s_mul_i32 s49, s26, 3
    s_add_u32 s49, s49, 28672
    s_add_u32 s58, s58, s49
    s_lshl_b32 s58, s58, 8
    s_add_u32 s59, s59, s49
    s_lshl_b32 s59, s59, 8
    v_and_b32 v8, 15, v0
    v_lshrrev_b32 v9, 4, v0
    v_lshrrev_b32_e64 v10, 2, v8
    v_lshl_add_u32 v14, v9, 3, v10
    v_lshlrev_b32 v14, 7, v14
    v_and_b32 v10, 3, v8
    v_lshl_add_u32 v14, v10, 3, v14
    v_lshrrev_b32 v10, 3, v8
    v_and_b32 v9, 1, v9
    v_lshl_add_u32 v10, v9, 1, v10
    v_lshl_add_u32 v14, v10, 5, v14
    v_lshrrev_b32_e64 v9, 4, v0
    v_lshl_add_u32 v6, v9, 10, s90
    v_lshl_add_u32 v6, v8, 4, v6
    s_mul_i32 s49, s3, 2304
    s_add_u32 s49, s49, 65536
    v_mul_u32_u24 v250, 144, v8
    v_lshl_add_u32 v250, v9, 3, v250
    v_add_u32 v250, s49, v250
    v_lshrrev_b32 v8, 3, v0
    v_and_b32_e64 v9, 7, v0
    v_mul_u32_u24 v251, 144, v8
    v_lshl_add_u32 v251, v9, 4, v251
    v_add_u32_e64 v251, s49, v251
    s_lshl_b32 s49, s44, 7
    s_add_u32 s49, s49, s91
    v_lshl_add_u32 v13, v8, 12, s49
    v_lshl_add_u32 v13, v9, 4, v13
    v_mov_b32 v18, s59
    v_mov_b32 v8, s58
    v_cmp_gt_u32 vcc, 32, v0
    v_and_b32 v9, 31, v0
    s_nop 0
    v_cndmask_b32 v18, v18, v8, vcc
    v_lshl_add_u32 v18, v9, 3, v18
    v_xor_b32 v15, 32, v14
    v_xor_b32 v16, 64, v14
    v_xor_b32 v17, 96, v14
    v_lshlrev_b32 v21, 7, v0
    v_mov_b32 v12, 1
    s_add_u32 s50, s56, 256
    s_and_b32 s50, s50, 0x380
    s_mul_i32 s51, s50, 1536
    s_mov_b32 s53, 1
    s_nop 0
    s_mov_b32 s54, 196608
    s_mov_b32 s55, 36864
    s_mov_b32 s59, 0x58
    s_mul_i32 s58, s27, 3
    s_add_u32 s58, s58, s3
    s_mul_i32 s58, s58, 1792
    s_lshl_b32 s49, s26, 18
    s_add_u32 s58, s58, s49
    s_add_u32 s58, s58, 0x9f5100
    v_mov_b32 v19, 147456
    s_cmp_eq_u32 s3, 0
    s_cbranch_scc1 L_lead
    s_branch LLA_issue
LLA_wait:
    s_waitcnt vmcnt(9)
    s_barrier
LLA_issue:
    s_add_u32 m0, s55, s52
    s_nop 0
    buffer_load_dwordx4 v40, s[28:31], s50 offen lds
    s_add_u32 m0, m0, 4096
    s_nop 0
    buffer_load_dwordx4 v41, s[28:31], s50 offen lds
    s_add_u32 m0, m0, 4096
    s_nop 0
    buffer_load_dwordx4 v42, s[28:31], s50 offen lds
    s_add_u32 m0, m0, 4096
    s_nop 0
    buffer_load_dwordx4 v43, s[32:35], s51 offen lds
    s_add_u32 m0, m0, 4096
    s_nop 0
    buffer_load_dwordx4 v44, s[32:35], s51 offen lds
    s_add_u32 m0, m0, 4096
    s_nop 0
    buffer_load_dwordx4 v45, s[32:35], s51 offen lds
    s_add_u32 m0, m0, 4096
    s_nop 0
    buffer_load_dwordx4 v46, s[32:35], s51 offen lds
    s_add_u32 m0, m0, 4096
    s_nop 0
    buffer_load_dwordx4 v47, s[32:35], s51 offen lds
    s_add_u32 m0, m0, 4096
    s_nop 0
    buffer_load_dwordx4 v48, s[32:35], s51 offen lds
LLA_nojob:
    s_cmp_eq_u32 s53, 3
    s_cselect_b32 s49, 3, 2
    s_lshl_b32 s49, s49, 7
    s_add_u32 s50, s50, s49
    s_and_b32 s50, s50, 0x380
    s_mul_i32 s51, s50, 1536
    s_add_u32 s53, s53, 1
    s_and_b32 s55, s53, 3
    s_mul_i32 s55, s55, 36864
    s_cmp_lt_u32 s53, 8
    s_cbranch_scc1 LLA_wait
    s_branch L_tail
L_lead:
    s_branch LLL_issue
LLL_wait:
    s_waitcnt vmcnt(9)
    s_barrier
LLL_issue:
    s_add_u32 m0, s55, s52
    s_nop 0
    buffer_load_dwordx4 v40, s[28:31], s50 offen lds
    s_add_u32 m0, m0, 4096
    s_nop 0
    buffer_load_dwordx4 v41, s[28:31], s50 offen lds
    s_add_u32 m0, m0, 4096
    s_nop 0
    buffer_load_dwordx4 v42, s[28:31], s50 offen lds
    s_add_u32 m0, m0, 4096
    s_nop 0
    buffer_load_dwordx4 v43, s[32:35], s51 offen lds
    s_add_u32 m0, m0, 4096
    s_nop 0
    buffer_load_dwordx4 v44, s[32:35], s51 offen lds
    s_add_u32 m0, m0, 4096
    s_nop 0
    buffer_load_dwordx4 v45, s[32:35], s51 offen lds
    s_add_u32 m0, m0, 4096
    s_nop 0
    buffer_load_dwordx4 v46, s[32:35], s51 offen lds
    s_add_u32 m0, m0, 4096
    s_nop 0
    buffer_load_dwordx4 v47, s[32:35], s51 offen lds
    s_add_u32 m0, m0, 4096
    s_nop 0
    buffer_load_dwordx4 v48, s[32:35], s51 offen lds
    s_bitcmp1_b32 s59, s53
    s_cbranch_scc0 LLL_nojob
    s_cmp_lg_u32 s53, 3
    s_cbranch_scc1 LLL_job2
    s_load_dwordx2 s[94:95], s[22:23], 0
    s_branch LLL_nojob
LLL_job2:
    s_cmp_lg_u32 s53, 4
    s_cbranch_scc1 LLL_job3
    s_waitcnt lgkmcnt(0)
    s_cmp_lg_u32 s95, 0
    s_cbranch_scc1 LLL_tagok
    s_mov_b32 s84, s22
    s_and_b32 s85, s23, 0xffff
    s_mov_b32 s86, 0x100
    s_mov_b32 s87, 0x20000
    v_mov_b32 v25, 0
    s_mov_b32 s49, 0
LLL_tag:
    buffer_load_dwordx2 v[22:23], v25, s[84:87], 0 offen sc1
    s_add_u32 s49, s49, 1
    s_waitcnt vmcnt(0)
    v_readfirstlane_b32 s94, v22
    v_readfirstlane_b32 s95, v23
    s_cmp_ge_u32 s49, 0x8000
    s_cbranch_scc1 LLL_tagok
    s_cmp_eq_u32 s95, 0
    s_cbranch_scc1 LLL_tag
LLL_tagok:
    s_mov_b32 s40, s24
    s_and_b32 s41, s25, 0xffff
    s_mov_b32 s42, 0x1000000
    s_mov_b32 s43, 0x20000
    s_lshl_b32 s49, s26, 8
    s_add_u32 s49, s49, 0x704000
    v_and_b32_e64 v24, 31, v0
    v_max_u32 v24, 8, v24
    v_lshl_add_u32 v24, v24, 2, s49
    s_getreg_b32 s96, hwreg(HW_REG_XCC_ID, 0, 4)
    s_lshl_b32 s49, s94, 4
    s_or_b32 s96, s96, s49
    v_mov_b32_e64 v23, s96
    s_lshl_b64 exec, 1, s27
    buffer_store_dword v23, v24, s[40:43], 0 offen sc1
    s_mov_b64 exec, -1
    v_mov_b32 v24, s94
    v_mov_b32 v25, s95
    v_mov_b32 v26, 0
    v_mov_b32 v27, 0
    v_mov_b32 v28, 0
    v_mov_b32_e64 v29, 0
    ds_write_b128 v19, v[24:27]
    ds_write_b128 v19, v[26:29] offset:16
    s_branch LLL_nojob
LLL_job3:
    s_lshl_b32 s49, s26, 8
    s_add_u32 s49, s49, 0x704000
    s_load_dwordx16 s[60:75], s[24:25], s49
    s_add_u32 s49, s49, 64
    s_load_dwordx16 s[76:91], s[24:25], s49
LLL_nojob:
    s_cmp_eq_u32 s53, 3
    s_cselect_b32 s49, 3, 2
    s_lshl_b32 s49, s49, 7
    s_add_u32 s50, s50, s49
    s_and_b32 s50, s50, 0x380
    s_mul_i32 s51, s50, 1536
    s_add_u32 s53, s53, 1
    s_and_b32 s55, s53, 3
    s_mul_i32 s55, s55, 36864
    s_cmp_lt_u32 s53, 8
    s_cbranch_scc1 LLL_wait
    s_waitcnt lgkmcnt(0)
    s_mov_b32 s97, s96
    s_xor_b64 s[56:57], s[68:69], s[96:97]
    s_xor_b64 s[58:59], s[70:71], s[96:97]
    s_or_b64 s[56:57], s[56:57], s[58:59]
    s_xor_b64 s[58:59], s[72:73], s[96:97]
    s_or_b64 s[56:57], s[56:57], s[58:59]
    s_xor_b64 s[58:59], s[74:75], s[96:97]
    s_or_b64 s[56:57], s[56:57], s[58:59]
    s_xor_b64 s[58:59], s[76:77], s[96:97]
    s_or_b64 s[56:57], s[56:57], s[58:59]
    s_xor_b64 s[58:59], s[78:79], s[96:97]
    s_or_b64 s[56:57], s[56:57], s[58:59]
    s_xor_b64 s[58:59], s[80:81], s[96:97]
    s_or_b64 s[56:57], s[56:57], s[58:59]
    s_xor_b64 s[58:59], s[82:83], s[96:97]
    s_or_b64 s[56:57], s[56:57], s[58:59]
    s_xor_b64 s[58:59], s[84:85], s[96:97]
    s_or_b64 s[56:57], s[56:57], s[58:59]
    s_xor_b64 s[58:59], s[86:87], s[96:97]
    s_or_b64 s[56:57], s[56:57], s[58:59]
    s_xor_b64 s[58:59], s[88:89], s[96:97]
    s_or_b64 s[56:57], s[56:57], s[58:59]
    s_xor_b64 s[58:59], s[90:91], s[96:97]
    s_or_b64 s[56:57], s[56:57], s[58:59]
    s_cmp_eq_u64 s[56:57], 0
    s_cbranch_scc1 LVA_known
    s_mov_b32 s40, s24
    s_nop 0
    s_and_b32 s41, s25, 0xffff
    s_mov_b32 s42, 0x1000000
    s_mov_b32 s43, 0x20000
    s_lshl_b32 s49, s26, 8
    s_add_u32 s49, s49, 0x704000
    v_and_b32_e64 v24, 31, v0
    v_max_u32 v24, 8, v24
    v_lshl_add_u32 v24, v24, 2, s49
    s_mov_b32 s49, 0
LVA_info:
    buffer_load_dword v26, v24, s[40:43], 0 offen sc1
    s_add_u32 s49, s49, 1
    s_waitcnt vmcnt(0)
    v_xor_b32_e64 v26, s96, v26
    v_cmp_gt_u32 vcc, 16, v26
    s_cmp_ge_u32 s49, 0x8000
    s_cbranch_scc1 LVA_infook
    s_cmp_lg_u64 vcc, -1
    s_cbranch_scc1 LVA_info
LVA_infook:
    v_cmp_eq_u32 vcc, 0, v26
    s_nop 0
    s_cmp_eq_u64 vcc, -1
LVA_known:
    s_cselect_b32 s56, 0x1000000, 0
    s_cselect_b32 s57, 0, 0x1000000
    s_cselect_b32 s58, 0xa00000, 0
    v_mov_b32 v28, s56
    v_mov_b32 v29, s57
    v_mov_b32 v30, s58
    v_mov_b32 v31, 0
    ds_write_b128 v19, v[28:31] offset:32
    s_waitcnt lgkmcnt(0)
    s_branch L_tail
L_B:
    s_and_b32 s48, s3, 1
    s_lshl_b32 s52, s3, 10
    s_lshl_b32 s49, s48, 4
    v_lshrrev_b32 v10, 2, v0
    v_add_u32 v10, s49, v10
    v_cvt_f32_u32 v10, v10
    v_mul_f32 v10, 0x3d000000, v10
    v_and_b32 v11, 3, v0
    v_lshlrev_b32 v11, 3, v11
    v_cvt_f32_u32 v11, v11
    s_cmp_ge_u32 s3, 2
    s_cselect_b32 s49, 0x3e800000, 0
    v_fma_f32 v32, v10, v11, s49
    v_add_f32 v33, v10, v32
    v_add_f32 v34, v10, v33
    v_add_f32 v35, v10, v34
    v_add_f32 v36, v10, v35
    v_add_f32 v37, v10, v36
    v_add_f32 v38, v10, v37
    v_add_f32 v39, v10, v38
    v_cos_f32 v32, v32
    v_cos_f32 v33, v33
    v_cos_f32 v34, v34
    v_cos_f32 v35, v35
    v_cos_f32 v36, v36
    v_cos_f32 v37, v37
    v_cos_f32 v38, v38
    v_cos_f32_e64 v39, v39
    v_cvt_pk_bf16_f32 v40, v32, v33
    v_cvt_pk_bf16_f32 v41, v34, v35
    v_cvt_pk_bf16_f32 v42, v36, v37
    v_cvt_pk_bf16_f32 v43, v38, v39
    s_add_u32 s49, s52, 143360
    v_lshl_add_u32 v10, v0, 4, s49
    ds_write_b128 v10, v[40:43]
    s_mov_b64 s[94:95], 0
    v_mov_b32 v24, s94
    v_mov_b32 v25, s95
    v_mov_b32 v26, 0
    v_mov_b32 v27, 0
    v_mov_b32 v28, 0
    v_mov_b32_e64 v29, 0
    ds_write_b128 v19, v[24:27]
    ds_write_b128 v19, v[26:29] offset:16
    s_mov_b64 exec, 0
    s_and_b32 s49, s3, 3
    s_cmp_lg_u32 s49, 0
    s_cbranch_scc1 Lw_b1_0
    s_cbranch_execz H_b1_0
Lw_b1_0:
    s_cmp_lg_u32 s49, 1
    s_cbranch_scc1 Lw_b1_1
    s_cbranch_execz H_b1_1
Lw_b1_1:
    s_cmp_lg_u32 s49, 2
    s_cbranch_scc1 Lw_b1_2
    s_cbranch_execz H_b1_2
Lw_b1_2:
    s_cbranch_execz H_b1_3
H_b1_ret:
    s_mov_b64 exec, -1
    s_waitcnt lgkmcnt(0)
    s_barrier
    s_lshl_b32 s68, s26, 2
    s_and_b32 s69, s27, 3
    s_add_u32 s68, s68, s69
    s_lshl_b32 s49, s48, 2
    v_or_b32 v40, s49, v3
    v_xor_b32 v40, v40, v2
    v_lshlrev_b32 v40, 4, v40
    v_lshl_add_u32 v40, v1, 17, v40
    v_lshlrev_b32 v42, 7, v0
    s_mov_b32 s36, s6
    s_and_b32 s37, s7, 0xffff
    s_mov_b32 s38, 0x180000
    s_mov_b32 s39, 0x20000
    s_lshl_b32 s53, s27, 2
    s_add_u32 s53, s53, s3
    s_lshl_b32 s49, s53, 10
    v_lshlrev_b32 v41, 15, v0
    s_mov_b32 exec_hi, 0xffff
    buffer_load_dword v248, v41, s[36:39], s49 offen offset:384
    s_mov_b64 exec, -1
    s_waitcnt vmcnt(1)
    s_barrier
    s_mov_b32 s28, s4
    s_and_b32 s29, s5, 0xffff
    s_mov_b32 s30, 0x200000
    s_mov_b32 s31, 0x20000
    s_and_b32 s50, s26, 3
    s_lshl_b32 s50, s50, 8
    s_mul_i32 s51, s53, 9
    s_add_u32 s50, s50, s51
    s_sub_u32 s50, s50, 16
    v_lshrrev_b32 v43, 2, v0
    v_add_u32 v43, s50, v43
    v_max_i32 v43, 0, v43
    v_lshlrev_b32 v43, 11, v43
    v_and_b32 v44, 3, v0
    v_lshl_add_u32 v43, v44, 8, v43
    s_lshr_b32 s50, s26, 2
    s_lshl_b32 s50, s50, 10
    s_mul_i32 s51, s26, 3
    s_andn2_b32 s51, 1, s51
    s_lshl_b32 s51, s51, 7
    s_add_u32 s50, s50, s51
    s_mov_b32 exec_hi, 15
    buffer_load_dword v248, v43, s[28:31], s50 offen
    s_mov_b64 exec, -1
    s_mov_b32 s64, s8
    s_nop 0
    s_and_b32 s65, s9, 0xffff
    s_mov_b32 s66, 0x80000
    s_mov_b32 s67, 0x20000
    s_lshl_b32 s50, s26, 5
    s_add_u32 s50, s50, s53
    s_lshl_b32 s50, s50, 11
    s_mov_b64 exec, 0xffff
    buffer_load_dword v248, v42, s[64:67], s50 offen
    v_lshlrev_b32_e64 v43, 10, v0
    s_lshl_b32 s50, s53, 14
    buffer_load_dword v248, v43, s[64:67], s50 offen offset:384
    s_mov_b64 exec, -1
    s_mov_b32 s76, s12
    s_and_b32 s77, s13, 0xffff
    s_mov_b32 s78, 0x800000
    s_mov_b32 s79, 0x20000
    s_mov_b32 s80, s14
    s_nop 0
    s_and_b32 s81, s15, 0xffff
    s_mov_b32 s82, 0x800000
    s_mov_b32 s83, 0x20000
    s_lshl_b32 s49, s3, 8
    s_add_u32 s49, s49, s68
    s_lshl_b32 s49, s49, 12
    s_add_u32 s50, s49, 0x400000
    s_add_u32 m0, s52, 147456
    s_nop 0
    buffer_load_dwordx4 v40, s[76:79], s49 offen lds
    s_add_u32 m0, m0, 4096
    s_nop 0
    buffer_load_dwordx4 v40, s[76:79], s50 offen lds
    s_add_u32 m0, m0, 4096
    s_nop 0
    buffer_load_dwordx4 v40, s[80:83], s49 offen lds
    s_add_u32 m0, m0, 4096
    s_nop 0
    buffer_load_dwordx4 v40, s[80:83], s50 offen lds
    s_cmp_lg_u32 s3, 0
    s_cbranch_scc1 L_b2
    s_load_dwordx2 s[94:95], s[22:23], 0
    s_waitcnt lgkmcnt(0)
    s_cmp_lg_u32 s95, 0
    s_cbranch_scc1 LLB_tagok
    s_mov_b32 s84, s22
    s_nop 0
    s_and_b32 s85, s23, 0xffff
    s_mov_b32 s86, 0x100
    s_mov_b32 s87, 0x20000
    v_mov_b32 v25, 0
    s_mov_b32 s49, 0
LLB_tag:
    buffer_load_dwordx2 v[22:23], v25, s[84:87], 0 offen sc1
    s_add_u32 s49, s49, 1
    s_waitcnt vmcnt(0)
    v_readfirstlane_b32 s94, v22
    v_readfirstlane_b32 s95, v23
    s_cmp_ge_u32 s49, 0x8000
    s_cbranch_scc1 LLB_tagok
    s_cmp_eq_u32 s95, 0
    s_cbranch_scc1 LLB_tag
LLB_tagok:
    v_mov_b32 v24, s94
    v_mov_b32_e64 v25, s95
    ds_write_b64 v19, v[24:25]
L_b2:
    s_mov_b64 exec, 0
    s_and_b32 s49, s3, 3
    s_cmp_lg_u32 s49, 0
    s_cbranch_scc1 Lw_b2_0
    s_cbranch_execz H_b2_0
Lw_b2_0:
    s_cmp_lg_u32 s49, 1
    s_cbranch_scc1 Lw_b2_1
    s_cbranch_execz H_b2_1
Lw_b2_1:
    s_cmp_lg_u32 s49, 2
    s_cbranch_scc1 Lw_b2_2
    s_cbranch_execz H_b2_2
Lw_b2_2:
    s_cbranch_execz H_b2_3
H_b2_ret:
    s_mov_b64 exec, -1
    s_mov_b64 exec, 0
    s_and_b32 s49, s3, 3
    s_cmp_lg_u32 s49, 0
    s_cbranch_scc1 Lw_f_0
    s_cbranch_execz H_f_0
Lw_f_0:
    s_cmp_lg_u32 s49, 1
    s_cbranch_scc1 Lw_f_1
    s_cbranch_execz H_f_1
Lw_f_1:
    s_cmp_lg_u32 s49, 2
    s_cbranch_scc1 Lw_f_2
    s_cbranch_execz H_f_2
Lw_f_2:
    s_cbranch_execz H_f_3
H_f_ret:
    s_mov_b64 exec, -1
    s_xor_b32 s46, s3, 4
    v_lshlrev_b32 v18, 7, v4
    v_lshl_add_u32 v18, v5, 3, v18
    v_add_u32 v18, 143360, v18
    ds_read_b64 v[24:25], v18
    ds_read_b64 v[26:27], v18 offset:2048
    v_lshlrev_b32_e64 v21, 6, v4
    v_lshl_add_u32 v21, v5, 4, v21
    s_mul_i32 s49, s46, 4128
    s_add_u32 s49, s49, 102400
    v_add_u32 v21, s49, v21
    v_and_b32 v6, 7, v4
    v_xor_b32 v6, v6, v5
    v_lshlrev_b32 v6, 4, v6
    v_lshl_add_u32 v6, v4, 7, v6
    s_lshl_b32 s49, s46, 12
    s_add_u32 s49, s49, 69632
    v_add_u32 v6, s49, v6
    v_xor_b32 v7, 64, v6
    v_xor_b32 v17, v1, v2
    v_lshlrev_b32_e64 v17, 4, v17
    v_lshl_add_u32 v17, v1, 7, v17
    v_add_u32_e64 v17, s49, v17
    v_xor_b32 v250, 0x380, v17
    v_sub_u32 v30, 0, v0
    v_and_b32 v30, 63, v30
    v_lshrrev_b32 v31, 3, v30
    v_and_b32 v30, 7, v30
    v_xor_b32 v30, v30, v31
    v_lshlrev_b32 v30, 4, v30
    v_lshl_add_u32 v30, v31, 7, v30
    v_cmp_eq_u32 vcc, 0, v0
    v_mov_b32 v31, 1024
    s_nop 0
    v_cndmask_b32 v31, v31, v0, vcc
    v_add3_u32 v30, v30, v31, s49
    v_xor_b32 v31, 1024, v30
    v_lshlrev_b32 v3, 4, v0
    s_mul_i32 s64, s45, 2176
    s_add_u32 s64, s64, 0x200000
    s_mul_i32 s49, s46, 278528
    s_sub_u32 s66, s64, s49
    s_add_u32 s64, s64, s49
    s_add_u32 s65, s64, 139264
    s_add_u32 s66, s66, 4456448
    s_sub_u32 s67, s66, 139264
    s_lshr_b32 s73, s45, 4
    s_add_u32 s73, s73, 128
    s_lshl_b32 s73, s73, 8
    s_and_b32 s74, s45, 15
    s_lshl_b32 s74, s74, 3
    s_add_u32 s73, s73, s74
    s_mov_b32 s58, 0x80008000
    s_mov_b32 s59, 0x80000000
    s_waitcnt lgkmcnt(0)
    s_mov_b32 s40, s24
    s_nop 0
    s_and_b32 s41, s25, 0xffff
    s_mov_b32 s42, 0x1000000
    s_mov_b32 s43, 0x20000
    v_xor_b32 v26, s58, v26
    v_xor_b32 v28, s58, v24
    v_xor_b32 v27, s58, v27
    v_xor_b32 v29, s58, v25
    v_xor_b32 v8, v4, v5
    v_lshrrev_b32 v8, 1, v8
    v_lshlrev_b32_e64 v8, 4, v8
    v_lshl_add_u32 v8, v4, 7, v8
    v_and_b32_e64 v15, 1, v5
    v_lshl_add_u32 v8, v15, 3, v8
    v_add_u32 v8, 147456, v8
    s_mov_b32 s56, 0x05040100
    s_mov_b32 s57, 0x07060302
    s_and_b32 s52, s27, 4
    s_add_u32 s52, s52, s3
    v_mul_u32_u24 v10, 8704, v5
    s_mul_i32 s53, s68, 139264
    s_lshl_b32 s49, s52, 8
    s_add_u32 s53, s53, s49
    s_add_u32 s53, s53, 0x200000
    v_lshl_add_u32 v10, v4, 4, v10
    v_add_u32 v10, s53, v10
    s_lshl_b32 s49, s26, 10
    s_add_u32 s49, s49, 0x708000
    v_lshl_add_u32 v18, v5, 8, s49
    v_lshl_add_u32 v18, v4, 3, v18
    v_lshl_add_u32 v13, v1, 5, s68
    v_lshlrev_b32_e64 v13, 11, v13
    v_lshl_add_u32 v13, v2, 4, v13
    s_lshl_b32 s49, s52, 7
    s_add_u32 s49, s49, 1024
    v_add_u32 v13, s49, v13
    v_and_b32 v14, 7, v4
    v_lshlrev_b32 v15, 1, v5
    v_xor_b32 v14, v14, v15
    v_lshlrev_b32 v14, 4, v14
    v_lshl_add_u32 v14, v4, 7, v14
    s_lshl_b32 s49, s3, 13
    v_add_u32 v14, s49, v14
    v_xor_b32_e64 v15, 16, v14
    v_and_b32 v11, 0x3ff, v17
    v_add_u32 v11, s49, v11
    s_mov_b32 s49, 0
LBl_watch:
    ds_read_b32 v22, v19 offset:28
    s_add_u32 s49, s49, 1
    s_waitcnt lgkmcnt(0)
    v_readfirstlane_b32 s51, v22
    s_nop 0
    s_cmp_ge_u32 s51, 3
    s_cbranch_scc1 LBl_seen
    s_sleep 2
    s_cmp_lt_u32 s49, 0x80000
    s_cbranch_scc1 LBl_watch
LBl_seen:
    s_setprio 1
    s_branch LBx_watch
L_tail:
    s_mov_b32 s64, s8
    s_nop 0
    s_and_b32 s65, s9, 0xffff
    s_mov_b32 s66, 0x80000
    s_mov_b32 s67, 0x20000
    s_mov_b32 m0, s52
    s_lshl_b32 s54, s93, 15
    s_mov_b32 s40, s24
    s_nop 0
    s_and_b32 s41, s25, 0xffff
    s_mov_b32 s42, 0x1000000
    s_mov_b32 s43, 0x20000
    buffer_load_dwordx4 v50, s[64:67], s54 offen lds
    s_add_u32 m0, m0, 4096
    s_add_u32 s54, s54, 0x8000
    s_and_b32 s54, s54, 0x7ffff
    buffer_load_dwordx4 v50, s[64:67], s54 offen lds
    s_waitcnt vmcnt(11)
    s_barrier
    s_add_u32 m0, m0, 4096
    s_add_u32 s54, s54, 0x8000
    s_and_b32 s54, s54, 0x7ffff
    buffer_load_dwordx4 v50, s[64:67], s54 offen lds
    s_add_u32 m0, m0, 4096
    s_add_u32 s54, s54, 0x8000
    s_and_b32 s54, s54, 0x7ffff
    buffer_load_dwordx4 v50, s[64:67], s54 offen lds
    s_add_u32 m0, m0, 4096
    s_add_u32 s54, s54, 0x8000
    s_and_b32 s54, s54, 0x7ffff
    buffer_load_dwordx4 v50, s[64:67], s54 offen lds
    s_add_u32 m0, m0, 4096
    s_add_u32 s54, s54, 0x8000
    s_and_b32 s54, s54, 0x7ffff
    buffer_load_dwordx4 v50, s[64:67], s54 offen lds
    s_add_u32 m0, m0, 4096
    s_add_u32 s54, s54, 0x8000
    s_and_b32 s54, s54, 0x7ffff
    buffer_load_dwordx4 v50, s[64:67], s54 offen lds
    s_waitcnt vmcnt(7)
    s_barrier
    s_add_u32 m0, m0, 4096
    s_add_u32 s54, s54, 0x8000
    s_and_b32 s54, s54, 0x7ffff
    buffer_load_dwordx4 v50, s[64:67], s54 offen lds
    s_waitcnt vmcnt(5)
    s_nop 0
    s_add_u32 m0, m0, 4096
    s_add_u32 s54, s54, 0x8000
    s_and_b32 s54, s54, 0x7ffff
    buffer_load_dwordx4 v50, s[64:67], s54 offen lds
    s_waitcnt vmcnt(5)
    s_nop 0
    s_add_u32 m0, m0, 4096
    s_add_u32 s54, s54, 0x8000
    s_and_b32 s54, s54, 0x7ffff
    buffer_load_dwordx4 v50, s[64:67], s54 offen lds
    s_waitcnt vmcnt(5)
    s_nop 0
    s_add_u32 m0, m0, 4096
    s_add_u32 s54, s54, 0x8000
    s_and_b32 s54, s54, 0x7ffff
    buffer_load_dwordx4 v50, s[64:67], s54 offen lds
    s_waitcnt vmcnt(5)
    s_nop 0
    s_add_u32 m0, m0, 4096
    s_add_u32 s54, s54, 0x8000
    s_and_b32 s54, s54, 0x7ffff
    buffer_load_dwordx4 v50, s[64:67], s54 offen lds
    s_waitcnt vmcnt(5)
    s_nop 0
    s_add_u32 m0, m0, 4096
    s_add_u32 s54, s54, 0x8000
    s_and_b32 s54, s54, 0x7ffff
    buffer_load_dwordx4 v50, s[64:67], s54 offen lds
    s_waitcnt vmcnt(5)
    s_nop 0
    s_add_u32 m0, m0, 4096
    s_add_u32 s54, s54, 0x8000
    s_and_b32 s54, s54, 0x7ffff
    buffer_load_dwordx4 v50, s[64:67], s54 offen lds
    s_waitcnt vmcnt(5)
    s_nop 0
    s_add_u32 m0, m0, 4096
    s_add_u32 s54, s54, 0x8000
    s_and_b32 s54, s54, 0x7ffff
    buffer_load_dwordx4 v50, s[64:67], s54 offen lds
    s_waitcnt vmcnt(5)
    s_nop 0
    s_add_u32 m0, m0, 4096
    s_add_u32 s54, s54, 0x8000
    s_and_b32 s54, s54, 0x7ffff
    buffer_load_dwordx4 v50, s[64:67], s54 offen lds
    s_mov_b32 s88, s20
    s_nop 0
    s_and_b32 s89, s21, 0xffff
    s_mov_b32 s90, 0x400000
    s_mov_b32 s91, 0x20000
    s_waitcnt vmcnt(0)
    s_mov_b64 exec, 1
    ds_add_u32 v19, v12 offset:20
    s_mov_b64 exec, -1
    s_mov_b32 s49, 0
LGs_watch:
    ds_read_b32 v20, v19 offset:20
    s_add_u32 s49, s49, 1
    s_waitcnt lgkmcnt(0)
    v_readfirstlane_b32 s51, v20
    s_nop 0
    s_cmp_ge_u32 s51, 4
    s_cbranch_scc1 LGs_seen
    s_cmp_lt_u32 s49, 0x80000
    s_cbranch_scc1 LGs_watch
    s_nop 0
LGs_seen:
    ds_read_b32 v23, v19 offset:40
    ds_read_b64 v[10:11], v19
    ds_read_b64_tr_b16 v[104:105], v14 offset:0
    ds_read_b64_tr_b16 v[106:107], v14 offset:512
    ds_read_b64_tr_b16 v[108:109], v15 offset:0
    ds_read_b64_tr_b16 v[110:111], v15 offset:512
    ds_read_b64_tr_b16 v[112:113], v16 offset:0
    ds_read_b64_tr_b16 v[114:115], v16 offset:512
    ds_read_b64_tr_b16 v[116:117], v17 offset:0
    ds_read_b64_tr_b16 v[118:119], v17 offset:512
    ds_read_b64_tr_b16 v[120:121], v14 offset:4096
    ds_read_b64_tr_b16 v[122:123], v14 offset:4608
    ds_read_b64_tr_b16 v[124:125], v15 offset:4096
    ds_read_b64_tr_b16 v[126:127], v15 offset:4608
    ds_read_b64_tr_b16 v[128:129], v16 offset:4096
    ds_read_b64_tr_b16 v[130:131], v16 offset:4608
    ds_read_b64_tr_b16 v[132:133], v17 offset:4096
    ds_read_b64_tr_b16 v[134:135], v17 offset:4608
    ds_read_b64_tr_b16 v[136:137], v14 offset:8192
    ds_read_b64_tr_b16 v[138:139], v14 offset:8704
    ds_read_b64_tr_b16 v[140:141], v15 offset:8192
    ds_read_b64_tr_b16 v[142:143], v15 offset:8704
    ds_read_b64_tr_b16 v[144:145], v16 offset:8192
    ds_read_b64_tr_b16 v[146:147], v16 offset:8704
    ds_read_b64_tr_b16 v[148:149], v17 offset:8192
    ds_read_b64_tr_b16 v[150:151], v17 offset:8704
    ds_read_b64_tr_b16 v[152:153], v14 offset:12288
    ds_read_b64_tr_b16 v[154:155], v14 offset:12800
    ds_read_b64_tr_b16 v[156:157], v15 offset:12288
    ds_read_b64_tr_b16 v[158:159], v15 offset:12800
    ds_read_b64_tr_b16 v[160:161], v16 offset:12288
    ds_read_b64_tr_b16 v[162:163], v16 offset:12800
    ds_read_b64_tr_b16 v[164:165], v17 offset:12288
    ds_read_b64_tr_b16 v[166:167], v17 offset:12800
    ds_read_b64_tr_b16 v[168:169], v14 offset:16384
    ds_read_b64_tr_b16 v[170:171], v14 offset:16896
    ds_read_b64_tr_b16 v[172:173], v15 offset:16384
    ds_read_b64_tr_b16 v[174:175], v15 offset:16896
    ds_read_b64_tr_b16 v[176:177], v16 offset:16384
    ds_read_b64_tr_b16 v[178:179], v16 offset:16896
    ds_read_b64_tr_b16 v[180:181], v17 offset:16384
    ds_read_b64_tr_b16 v[182:183], v17 offset:16896
    ds_read_b64_tr_b16 v[184:185], v14 offset:20480
    ds_read_b64_tr_b16 v[186:187], v14 offset:20992
    ds_read_b64_tr_b16 v[188:189], v15 offset:20480
    ds_read_b64_tr_b16 v[190:191], v15 offset:20992
    ds_read_b64_tr_b16 v[192:193], v16 offset:20480
    ds_read_b64_tr_b16 v[194:195], v16 offset:20992
    ds_read_b64_tr_b16 v[196:197], v17 offset:20480
    ds_read_b64_tr_b16 v[198:199], v17 offset:20992
    ds_read_b64_tr_b16 v[200:201], v14 offset:24576
    ds_read_b64_tr_b16 v[202:203], v14 offset:25088
    ds_read_b64_tr_b16 v[204:205], v15 offset:24576
    ds_read_b64_tr_b16 v[206:207], v15 offset:25088
    ds_read_b64_tr_b16 v[208:209], v16 offset:24576
    ds_read_b64_tr_b16 v[210:211], v16 offset:25088
    ds_read_b64_tr_b16 v[212:213], v17 offset:24576
    ds_read_b64_tr_b16 v[214:215], v17 offset:25088
    ds_read_b64_tr_b16 v[216:217], v14 offset:28672
    ds_read_b64_tr_b16 v[218:219], v14 offset:29184
    ds_read_b64_tr_b16 v[220:221], v15 offset:28672
    ds_read_b64_tr_b16 v[222:223], v15 offset:29184
    ds_read_b64_tr_b16 v[224:225], v16 offset:28672
    ds_read_b64_tr_b16 v[226:227], v16 offset:29184
    ds_read_b64_tr_b16 v[228:229], v17 offset:28672
    ds_read_b64_tr_b16 v[230:231], v17 offset:29184
    ds_read_b64_tr_b16 v[232:233], v14 offset:32768
    ds_read_b64_tr_b16 v[234:235], v14 offset:33280
    ds_read_b64_tr_b16 v[236:237], v15 offset:32768
    ds_read_b64_tr_b16 v[238:239], v15 offset:33280
    ds_read_b64_tr_b16 v[240:241], v16 offset:32768
    ds_read_b64_tr_b16 v[242:243], v16 offset:33280
    ds_read_b64_tr_b16 v[244:245], v17 offset:32768
    ds_read_b64_tr_b16 v[246:247], v17 offset:33280
    s_waitcnt lgkmcnt(0)
    v_add_u32_e64 v6, v23, v6
    s_lshl_b32 s54, s93, 12
    s_movk_i32 s55, 0x1000
    s_mov_b32 s49, 0
LG_poll:
    buffer_load_dwordx2 v[20:21], v18, s[40:43], 0 offen sc1
    s_add_u32 s49, s49, 1
    s_waitcnt vmcnt(0)
    v_cmp_ne_u64 vcc, v[10:11], v[20:21]
    s_nop 4
    s_cbranch_vccz LG_go
    s_cmp_lt_u32 s49, 0x8000
    s_cbranch_scc1 LG_poll
LG_go:
    s_setprio 2
    s_nop 0
    buffer_load_dwordx4 v[24:27], v6, s[40:43], s54 offen sc1
    s_add_u32 s54, s54, 0x1000
    s_and_b32 s54, s54, 0xffff
    buffer_load_dwordx4 v[28:31], v6, s[40:43], s54 offen sc1
    s_add_u32 s54, s54, 0x1000
    s_and_b32 s54, s54, 0xffff
    buffer_load_dwordx4 v[32:35], v6, s[40:43], s54 offen sc1
    s_add_u32 s54, s54, 0x1000
    s_and_b32 s54, s54, 0xffff
    buffer_load_dwordx4 v[36:39], v6, s[40:43], s54 offen sc1
    s_add_u32 s54, s54, 0x1000
    s_and_b32 s54, s54, 0xffff
    buffer_load_dwordx4 v[40:43], v6, s[40:43], s54 offen sc1
    s_add_u32 s54, s54, 0x1000
    s_and_b32 s54, s54, 0xffff
    buffer_load_dwordx4 v[44:47], v6, s[40:43], s54 offen sc1
    s_add_u32 s54, s54, 0x1000
    s_and_b32 s54, s54, 0xffff
    buffer_load_dwordx4 v[48:51], v6, s[40:43], s54 offen sc1
    s_waitcnt vmcnt(6)
    s_add_u32 s54, s54, s55
    v_mfma_f32_16x16x32_bf16 v[88:91], v[104:107], v[24:27], 0
    s_and_b32 s54, s54, 0xffff
    buffer_load_dwordx4 v[52:55], v6, s[40:43], s54 offen sc1
    v_mfma_f32_16x16x32_bf16 v[92:95], v[108:111], v[24:27], 0
    v_mfma_f32_16x16x32_bf16 v[96:99], v[112:115], v[24:27], 0
    v_mfma_f32_16x16x32_bf16 v[100:103], v[116:119], v[24:27], 0
    s_waitcnt vmcnt(6)
    s_add_u32 s54, s54, s55
    v_mfma_f32_16x16x32_bf16 v[88:91], v[120:123], v[28:31], v[88:91]
    s_and_b32 s54, s54, 0xffff
    buffer_load_dwordx4 v[56:59], v6, s[40:43], s54 offen sc1
    ds_read_b64_tr_b16 v[104:105], v14 offset:36864
    v_mfma_f32_16x16x32_bf16 v[92:95], v[124:127], v[28:31], v[92:95]
    ds_read_b64_tr_b16 v[106:107], v14 offset:37376
    v_mfma_f32_16x16x32_bf16 v[96:99], v[128:131], v[28:31], v[96:99]
    ds_read_b64_tr_b16 v[108:109], v15 offset:36864
    v_mfma_f32_16x16x32_bf16 v[100:103], v[132:135], v[28:31], v[100:103]
    ds_read_b64_tr_b16 v[110:111], v15 offset:37376
    ds_read_b64_tr_b16 v[112:113], v16 offset:36864
    s_waitcnt vmcnt(6)
    s_add_u32 s54, s54, s55
    v_mfma_f32_16x16x32_bf16 v[88:91], v[136:139], v[32:35], v[88:91]
    s_and_b32 s54, s54, 0xffff
    buffer_load_dwordx4 v[60:63], v6, s[40:43], s54 offen sc1
    ds_read_b64_tr_b16 v[114:115], v16 offset:37376
    v_mfma_f32_16x16x32_bf16 v[92:95], v[140:143], v[32:35], v[92:95]
    ds_read_b64_tr_b16 v[116:117], v17 offset:36864
    v_mfma_f32_16x16x32_bf16 v[96:99], v[144:147], v[32:35], v[96:99]
    ds_read_b64_tr_b16 v[118:119], v17 offset:37376
    v_mfma_f32_16x16x32_bf16 v[100:103], v[148:151], v[32:35], v[100:103]
    ds_read_b64_tr_b16 v[120:121], v14 offset:40960
    ds_read_b64_tr_b16 v[122:123], v14 offset:41472
    s_waitcnt vmcnt(6)
    s_add_u32 s54, s54, s55
    v_mfma_f32_16x16x32_bf16 v[88:91], v[152:155], v[36:39], v[88:91]
    s_and_b32 s54, s54, 0xffff
    buffer_load_dwordx4 v[64:67], v6, s[40:43], s54 offen sc1
    ds_read_b64_tr_b16 v[124:125], v15 offset:40960
    v_mfma_f32_16x16x32_bf16 v[92:95], v[156:159], v[36:39], v[92:95]
    ds_read_b64_tr_b16 v[126:127], v15 offset:41472
    v_mfma_f32_16x16x32_bf16 v[96:99], v[160:163], v[36:39], v[96:99]
    ds_read_b64_tr_b16 v[128:129], v16 offset:40960
    v_mfma_f32_16x16x32_bf16 v[100:103], v[164:167], v[36:39], v[100:103]
    ds_read_b64_tr_b16 v[130:131], v16 offset:41472
    ds_read_b64_tr_b16 v[132:133], v17 offset:40960
    s_waitcnt vmcnt(6)
    s_add_u32 s54, s54, s55
    v_mfma_f32_16x16x32_bf16 v[88:91], v[168:171], v[40:43], v[88:91]
    s_and_b32 s54, s54, 0xffff
    buffer_load_dwordx4 v[68:71], v6, s[40:43], s54 offen sc1
    ds_read_b64_tr_b16 v[134:135], v17 offset:41472
    v_mfma_f32_16x16x32_bf16 v[92:95], v[172:175], v[40:43], v[92:95]
    ds_read_b64_tr_b16 v[136:137], v14 offset:45056
    v_mfma_f32_16x16x32_bf16 v[96:99], v[176:179], v[40:43], v[96:99]
    ds_read_b64_tr_b16 v[138:139], v14 offset:45568
    v_mfma_f32_16x16x32_bf16 v[100:103], v[180:183], v[40:43], v[100:103]
    ds_read_b64_tr_b16 v[140:141], v15 offset:45056
    ds_read_b64_tr_b16 v[142:143], v15 offset:45568
    s_waitcnt vmcnt(6)
    s_add_u32 s54, s54, s55
    v_mfma_f32_16x16x32_bf16 v[88:91], v[184:187], v[44:47], v[88:91]
    s_and_b32 s54, s54, 0xffff
    buffer_load_dwordx4 v[72:75], v6, s[40:43], s54 offen sc1
    ds_read_b64_tr_b16 v[144:145], v16 offset:45056
    v_mfma_f32_16x16x32_bf16 v[92:95], v[188:191], v[44:47], v[92:95]
    ds_read_b64_tr_b16 v[146:147], v16 offset:45568
    v_mfma_f32_16x16x32_bf16 v[96:99], v[192:195], v[44:47], v[96:99]
    ds_read_b64_tr_b16 v[148:149], v17 offset:45056
    v_mfma_f32_16x16x32_bf16 v[100:103], v[196:199], v[44:47], v[100:103]
    ds_read_b64_tr_b16 v[150:151], v17 offset:45568
    ds_read_b64_tr_b16 v[152:153], v14 offset:49152
    s_waitcnt vmcnt(6)
    s_add_u32 s54, s54, s55
    v_mfma_f32_16x16x32_bf16 v[88:91], v[200:203], v[48:51], v[88:91]
    s_and_b32 s54, s54, 0xffff
    buffer_load_dwordx4 v[76:79], v6, s[40:43], s54 offen sc1
    ds_read_b64_tr_b16 v[154:155], v14 offset:49664
    v_mfma_f32_16x16x32_bf16 v[92:95], v[204:207], v[48:51], v[92:95]
    ds_read_b64_tr_b16 v[156:157], v15 offset:49152
    v_mfma_f32_16x16x32_bf16 v[96:99], v[208:211], v[48:51], v[96:99]
    ds_read_b64_tr_b16 v[158:159], v15 offset:49664
    v_mfma_f32_16x16x32_bf16 v[100:103], v[212:215], v[48:51], v[100:103]
    ds_read_b64_tr_b16 v[160:161], v16 offset:49152
    ds_read_b64_tr_b16 v[162:163], v16 offset:49664
    s_waitcnt vmcnt(6)
    s_add_u32 s54, s54, s55
    v_mfma_f32_16x16x32_bf16 v[88:91], v[216:219], v[52:55], v[88:91]
    s_and_b32 s54, s54, 0xffff
    buffer_load_dwordx4 v[80:83], v6, s[40:43], s54 offen sc1
    ds_read_b64_tr_b16 v[164:165], v17 offset:49152
    v_mfma_f32_16x16x32_bf16 v[92:95], v[220:223], v[52:55], v[92:95]
    ds_read_b64_tr_b16 v[166:167], v17 offset:49664
    v_mfma_f32_16x16x32_bf16 v[96:99], v[224:227], v[52:55], v[96:99]
    ds_read_b64_tr_b16 v[168:169], v14 offset:53248
    v_mfma_f32_16x16x32_bf16 v[100:103], v[228:231], v[52:55], v[100:103]
    ds_read_b64_tr_b16 v[170:171], v14 offset:53760
    ds_read_b64_tr_b16 v[172:173], v15 offset:53248
    s_waitcnt vmcnt(6)
    s_add_u32 s54, s54, s55
    v_mfma_f32_16x16x32_bf16 v[88:91], v[232:235], v[56:59], v[88:91]
    s_and_b32 s54, s54, 0xffff
    buffer_load_dwordx4 v[84:87], v6, s[40:43], s54 offen sc1
    ds_read_b64_tr_b16 v[174:175], v15 offset:53760
    v_mfma_f32_16x16x32_bf16 v[92:95], v[236:239], v[56:59], v[92:95]
    ds_read_b64_tr_b16 v[176:177], v16 offset:53248
    v_mfma_f32_16x16x32_bf16 v[96:99], v[240:243], v[56:59], v[96:99]
    ds_read_b64_tr_b16 v[178:179], v16 offset:53760
    v_mfma_f32_16x16x32_bf16 v[100:103], v[244:247], v[56:59], v[100:103]
    ds_read_b64_tr_b16 v[180:181], v17 offset:53248
    ds_read_b64_tr_b16 v[182:183], v17 offset:53760
    s_waitcnt vmcnt(6) lgkmcnt(14)
    s_nop 0
    v_mfma_f32_16x16x32_bf16 v[88:91], v[104:107], v[60:63], v[88:91]
    ds_read_b64_tr_b16 v[184:185], v14 offset:57344
    v_mfma_f32_16x16x32_bf16 v[92:95], v[108:111], v[60:63], v[92:95]
    ds_read_b64_tr_b16 v[186:187], v14 offset:57856
    v_mfma_f32_16x16x32_bf16 v[96:99], v[112:115], v[60:63], v[96:99]
    ds_read_b64_tr_b16 v[188:189], v15 offset:57344
    v_mfma_f32_16x16x32_bf16 v[100:103], v[116:119], v[60:63], v[100:103]
    ds_read_b64_tr_b16 v[190:191], v15 offset:57856
    ds_read_b64_tr_b16 v[192:193], v16 offset:57344
    s_waitcnt vmcnt(5) lgkmcnt(14)
    s_nop 0
    v_mfma_f32_16x16x32_bf16 v[88:91], v[120:123], v[64:67], v[88:91]
    ds_read_b64_tr_b16 v[194:195], v16 offset:57856
    v_mfma_f32_16x16x32_bf16 v[92:95], v[124:127], v[64:67], v[92:95]
    ds_read_b64_tr_b16 v[196:197], v17 offset:57344
    v_mfma_f32_16x16x32_bf16 v[96:99], v[128:131], v[64:67], v[96:99]
    ds_read_b64_tr_b16 v[198:199], v17 offset:57856
    v_mfma_f32_16x16x32_bf16 v[100:103], v[132:135], v[64:67], v[100:103]
    ds_read_b64_tr_b16 v[200:201], v14 offset:61440
    ds_read_b64_tr_b16 v[202:203], v14 offset:61952
    s_waitcnt vmcnt(4) lgkmcnt(14)
    s_nop 0
    v_mfma_f32_16x16x32_bf16 v[88:91], v[136:139], v[68:71], v[88:91]
    ds_read_b64_tr_b16 v[204:205], v15 offset:61440
    v_mfma_f32_16x16x32_bf16 v[92:95], v[140:143], v[68:71], v[92:95]
    ds_read_b64_tr_b16 v[206:207], v15 offset:61952
    v_mfma_f32_16x16x32_bf16 v[96:99], v[144:147], v[68:71], v[96:99]
    ds_read_b64_tr_b16 v[208:209], v16 offset:61440
    v_mfma_f32_16x16x32_bf16 v[100:103], v[148:151], v[68:71], v[100:103]
    ds_read_b64_tr_b16 v[210:211], v16 offset:61952
    ds_read_b64_tr_b16 v[212:213], v17 offset:61440
    s_waitcnt vmcnt(3) lgkmcnt(14)
    s_nop 0
    v_mfma_f32_16x16x32_bf16 v[88:91], v[152:155], v[72:75], v[88:91]
    ds_read_b64_tr_b16 v[214:215], v17 offset:61952
    v_mfma_f32_16x16x32_bf16 v[92:95], v[156:159], v[72:75], v[92:95]
    v_mfma_f32_16x16x32_bf16 v[96:99], v[160:163], v[72:75], v[96:99]
    v_mfma_f32_16x16x32_bf16 v[100:103], v[164:167], v[72:75], v[100:103]
    s_waitcnt vmcnt(2) lgkmcnt(14)
    s_nop 0
    v_mfma_f32_16x16x32_bf16 v[88:91], v[168:171], v[76:79], v[88:91]
    v_mfma_f32_16x16x32_bf16 v[92:95], v[172:175], v[76:79], v[92:95]
    v_mfma_f32_16x16x32_bf16 v[96:99], v[176:179], v[76:79], v[96:99]
    v_mfma_f32_16x16x32_bf16 v[100:103], v[180:183], v[76:79], v[100:103]
    s_waitcnt vmcnt(1) lgkmcnt(8)
    s_nop 0
    v_mfma_f32_16x16x32_bf16 v[88:91], v[184:187], v[80:83], v[88:91]
    v_mfma_f32_16x16x32_bf16 v[92:95], v[188:191], v[80:83], v[92:95]
    v_mfma_f32_16x16x32_bf16 v[96:99], v[192:195], v[80:83], v[96:99]
    v_mfma_f32_16x16x32_bf16 v[100:103], v[196:199], v[80:83], v[100:103]
    s_waitcnt vmcnt(0) lgkmcnt(0)
    s_nop 0
    v_mfma_f32_16x16x32_bf16 v[88:91], v[200:203], v[84:87], v[88:91]
    v_mfma_f32_16x16x32_bf16 v[92:95], v[204:207], v[84:87], v[92:95]
    v_mfma_f32_16x16x32_bf16 v[96:99], v[208:211], v[84:87], v[96:99]
    v_mfma_f32_16x16x32_bf16 v[100:103], v[212:215], v[84:87], v[100:103]
    s_nop 4
    s_nop 0
    v_cvt_pk_bf16_f32 v88, v88, v89
    v_cvt_pk_bf16_f32 v89, v90, v91
    ds_write_b64 v250, v[88:89] offset:0
    v_cvt_pk_bf16_f32 v92, v92, v93
    v_cvt_pk_bf16_f32 v93, v94, v95
    ds_write_b64 v250, v[92:93] offset:32
    v_cvt_pk_bf16_f32 v96, v96, v97
    v_cvt_pk_bf16_f32 v97, v98, v99
    ds_write_b64 v250, v[96:97] offset:64
    v_cvt_pk_bf16_f32 v100, v100, v101
    v_cvt_pk_bf16_f32 v101, v102, v103
    ds_write_b64 v250, v[100:101] offset:96
    ds_read_b128 v[24:27], v251 offset:0
    ds_read_b128 v[28:31], v251 offset:1152
    s_mov_b32 s54, 0x8000
    s_waitcnt lgkmcnt(1)
    buffer_store_dwordx4 v[24:27], v13, s[88:91], 0 offen sc1
    s_waitcnt lgkmcnt(0)
    buffer_store_dwordx4 v[28:31], v13, s[88:91], s54 offen sc1
    s_endpgm
L_Acons:
    s_lshl_b32 s49, s27, 2
    s_add_u32 s49, s49, s3
    s_sub_u32 s49, s49, 36
    s_lshr_b32 s66, s49, 1
    s_lshl_b32 s66, s66, 10
    s_and_b32 s49, s49, 1
    s_lshl_b32 s49, s49, 6
    s_add_u32 s66, s66, s49
    s_mul_i32 s49, s26, 3
    s_add_u32 s49, s49, 6
    s_waitcnt lgkmcnt(0)
    s_and_b32 s49, s49, 7
    s_mul_i32 s67, s49, 196608
    s_add_u32 s67, s67, s66
    s_load_dword s97, s[6:7], s67 offset:384
    s_load_dword s97, s[6:7], s67 offset:49536
    s_load_dword s97, s[6:7], s67 offset:98688
    s_load_dword s97, s[6:7], s67 offset:147840
    s_add_u32 s49, s49, 2
    s_and_b32 s49, s49, 7
    s_mul_i32 s67, s49, 196608
    s_add_u32 s67, s67, s66
    s_nop 0
    s_load_dword s97, s[6:7], s67 offset:384
    s_load_dword s97, s[6:7], s67 offset:49536
    s_load_dword s97, s[6:7], s67 offset:98688
    s_load_dword s97, s[6:7], s67 offset:147840
    s_add_u32 s49, s49, 2
    s_setprio 1
    s_sub_u32 s48, s3, 4
    v_and_b32 v1, 15, v0
    v_lshrrev_b32 v2, 4, v0
    v_lshrrev_b32 v5, 1, v1
    v_xor_b32 v5, v5, v2
    v_lshlrev_b32 v5, 4, v5
    v_lshl_add_u32 v4, v1, 7, v5
    v_xor_b32 v5, 64, v4
    v_and_b32 v1, 15, v0
    v_lshrrev_b32 v2, 4, v0
    v_lshrrev_b32 v3, 2, v1
    v_lshl_add_u32 v6, v2, 3, v3
    v_lshlrev_b32 v6, 7, v6
    v_and_b32 v3, 3, v1
    v_lshl_add_u32 v6, v3, 3, v6
    v_lshrrev_b32 v3, 3, v1
    v_and_b32 v2, 1, v2
    v_lshl_add_u32 v3, v2, 1, v3
    v_lshl_add_u32 v6, v3, 5, v6
    s_lshl_b32 s49, s48, 5
    v_xor_b32 v6, s49, v6
    v_mov_b32 v112, 0
    v_mov_b32 v113, 0
    v_mov_b32_e64 v114, 0
    v_mov_b32 v115, 0
    s_nop 1
    v_mfma_f32_32x32x16_bf16 v[32:47], v[112:115], v[112:115], 0
    v_mfma_f32_32x32x16_bf16 v[48:63], v[112:115], v[112:115], 0
    v_mfma_f32_32x32x16_bf16 v[64:79], v[112:115], v[112:115], 0
    v_mfma_f32_32x32x16_bf16 v[80:95], v[112:115], v[112:115], 0
    v_mfma_f32_32x32x16_bf16 v[96:111], v[112:115], v[112:115], 0
    v_and_b32 v1, 15, v0
    v_lshrrev_b32 v2, 4, v0
    v_lshlrev_b32 v3, 2, v2
    v_sub_u32 v3, v1, v3
    v_mov_b32 v7, 0xf149f2ca
    v_mov_b32 v16, 0
    v_mov_b32 v17, 0
    s_mov_b32 s56, 0xffff
    s_mov_b32 s57, 0xffff0000
    v_subrev_u32 v22, 0, v3
    v_cmp_gt_u32 vcc, 8, v22
    v_mov_b32 v25, s56
    v_add_u32 v22, 16, v22
    v_cndmask_b32 v8, v7, v112, vcc
    v_cndmask_b32 v25, v112, v25, vcc
    v_cmp_gt_u32 vcc, 8, v22
    v_or_b32 v16, v16, v25
    s_nop 0
    v_cndmask_b32 v12, v7, v112, vcc
    v_subrev_u32 v22, 1, v3
    v_cmp_gt_u32 vcc, 8, v22
    v_mov_b32 v25, s57
    v_add_u32 v22, 16, v22
    v_cndmask_b32 v9, v7, v112, vcc
    v_cndmask_b32 v25, v112, v25, vcc
    v_cmp_gt_u32 vcc, 8, v22
    v_or_b32 v16, v16, v25
    s_nop 0
    v_cndmask_b32 v13, v7, v112, vcc
    v_subrev_u32 v22, 2, v3
    v_cmp_gt_u32 vcc, 8, v22
    v_mov_b32 v25, s56
    v_add_u32 v22, 16, v22
    v_cndmask_b32 v10, v7, v112, vcc
    v_cndmask_b32 v25, v112, v25, vcc
    v_cmp_gt_u32 vcc, 8, v22
    v_or_b32 v17, v17, v25
    s_nop 0
    v_cndmask_b32 v14, v7, v112, vcc
    v_subrev_u32 v22, 3, v3
    v_cmp_gt_u32 vcc, 8, v22
    v_mov_b32 v25, s57
    v_add_u32 v22, 16, v22
    v_cndmask_b32 v11, v7, v112, vcc
    v_cndmask_b32 v25, v112, v25, vcc
    v_cmp_gt_u32 vcc, 8, v22
    v_or_b32 v17, v17, v25
    s_nop 0
    v_cndmask_b32 v15, v7, v112, vcc
    v_not_b32 v18, v16
    v_not_b32 v19, v17
    v_mov_b32 v20, 0x3f803f80
    v_mov_b32 v21, 0x3f803f80
    s_lshl_b32 s49, s46, 10
    s_add_u32 s49, s49, s47
    v_and_b32 v22, 31, v0
    v_add_u32 v28, s49, v22
    s_lshl_b32 s49, s44, 2
    s_add_u32 s49, s49, s48
    s_lshl_b32 s49, s49, 11
    v_lshrrev_b32 v23, 5, v0
    v_lshl_add_u32 v29, v23, 10, s49
    v_lshrrev_b32_e64 v23, 6, v28
    v_lshl_add_u32 v27, v23, 16, v29
    v_and_b32_e64 v23, 63, v28
    v_lshl_add_u32 v27, v23, 4, v27
    v_add_u32 v28, 32, v28
    v_lshrrev_b32 v23, 6, v28
    v_lshl_add_u32 v26, v23, 16, v29
    v_and_b32_e64 v23, 63, v28
    v_lshl_add_u32 v26, v23, 4, v26
    v_add_u32 v28, 32, v28
    v_lshrrev_b32 v23, 6, v28
    v_lshl_add_u32 v25, v23, 16, v29
    v_and_b32_e64 v23, 63, v28
    v_lshl_add_u32 v25, v23, 4, v25
    s_cmp_eq_u32 s45, 0
    s_cselect_b32 s49, 16, 8
    s_cmp_eq_u32 s47, 0
    s_cselect_b32 s49, 0, s49
    s_cselect_b32 s51, 16, 32
    v_mov_b32 v23, 0x80000000
    v_cmp_gt_u32 vcc, s49, v22
    s_nop 1
    v_cndmask_b32 v27, v27, v23, vcc
    v_cmp_gt_u32 vcc, s51, v22
    s_nop 1
    v_cndmask_b32 v25, v23, v25, vcc
    s_mul_i32 s68, s45, 5
    s_min_u32 s49, s45, 1
    s_add_u32 s68, s68, s49
    s_lshl_b32 s93, s44, 1
    s_mul_i32 s49, s45, 5
    s_add_u32 s93, s93, s49
    s_and_b32 s93, s93, 15
    s_lshr_b32 s49, s48, 1
    s_add_u32 s68, s68, s49
    s_add_u32 s68, s68, 4
    s_lshl_b32 s49, s26, 4
    s_add_u32 s49, s49, s68
    s_lshr_b32 s90, s49, 2
    s_lshl_b32 s90, s90, 8
    s_and_b32 s91, s49, 3
    s_add_u32 s90, s90, s91
    s_lshl_b32 s90, s90, 8
    s_and_b32 s91, s49, 63
    s_lshl_b32 s91, s91, 5
    s_lshr_b32 s49, s49, 6
    s_add_u32 s91, s91, s49
    s_lshl_b32 s91, s91, 11
    s_cmp_ge_u32 s68, 5
    s_cselect_b32 s58, 1, 0
    s_mov_b32 s59, s58
    s_cmp_ge_u32 s68, 11
    s_cmov_b32 s58, 2
    s_cmp_ge_u32 s68, 10
    s_cmov_b32 s59, 2
    s_mul_i32 s49, s26, 3
    s_add_u32 s49, s49, 28672
    s_add_u32 s58, s58, s49
    s_lshl_b32 s58, s58, 8
    s_add_u32 s59, s59, s49
    s_lshl_b32 s59, s59, 8
    v_and_b32 v22, 15, v0
    v_lshrrev_b32 v23, 4, v0
    v_lshrrev_b32 v24, 2, v22
    v_lshl_add_u32 v253, v23, 3, v24
    v_lshlrev_b32 v253, 7, v253
    v_and_b32 v24, 3, v22
    v_lshl_add_u32 v253, v24, 3, v253
    v_lshrrev_b32 v24, 3, v22
    v_and_b32 v23, 1, v23
    v_lshl_add_u32 v24, v23, 1, v24
    v_lshl_add_u32 v253, v24, 5, v253
    v_lshrrev_b32_e64 v23, 4, v0
    v_lshl_add_u32 v30, v23, 10, s90
    v_lshl_add_u32 v30, v22, 4, v30
    s_mul_i32 s49, s3, 2304
    s_add_u32 s49, s49, 65536
    v_mul_u32_u24 v254, 144, v22
    v_lshl_add_u32 v254, v23, 3, v254
    v_add_u32 v254, s49, v254
    v_lshrrev_b32 v22, 3, v0
    v_and_b32_e64 v23, 7, v0
    v_mul_u32_u24 v255, 144, v22
    v_lshl_add_u32 v255, v23, 4, v255
    v_add_u32_e64 v255, s49, v255
    s_lshl_b32 s49, s44, 7
    s_add_u32 s49, s49, s91
    v_lshl_add_u32 v31, v22, 12, s49
    v_lshl_add_u32 v31, v23, 4, v31
    v_mov_b32 v252, s59
    v_mov_b32 v22, s58
    v_cmp_gt_u32 vcc, 32, v0
    v_and_b32 v23, 31, v0
    s_nop 0
    v_cndmask_b32 v252, v252, v22, vcc
    v_lshl_add_u32 v252, v23, 3, v252
    s_and_b32 s49, s48, 1
    s_lshl_b32 s49, s49, 3
    s_add_u32 s93, s93, s49
    s_lshl_b32 s93, s93, 12
    s_lshl_b32 s49, s49, 12
    v_add_u32_e64 v253, s49, v253
    s_mov_b32 s88, s20
    s_and_b32 s89, s21, 0xffff
    s_mov_b32 s90, 0x400000
    s_mov_b32 s91, 0x20000
    v_mov_b32 v7, 147456
    s_mov_b32 s40, s24
    s_nop 0
    s_and_b32 s41, s25, 0xffff
    s_mov_b32 s42, 0x1000000
    s_mov_b32 s43, 0x20000
    s_mov_b32 s28, s24
    s_and_b32 s29, s25, 0xffff
    s_mov_b32 s30, 0x0
    s_mov_b32 s31, 0x20000
    s_mov_b32 s32, s24
    s_and_b32 s33, s25, 0xffff
    s_mov_b32 s34, 0x0
    s_mov_b32 s35, 0x20000
    s_mul_i32 s73, s26, 3
    s_add_u32 s73, s73, s45
    s_lshl_b32 s73, s73, 8
    s_lshl_b32 s74, s44, 2
    s_add_u32 s74, s74, s48
    s_lshl_b32 s74, s74, 3
    s_add_u32 s74, s74, 0x700000
    s_add_u32 s73, s73, s74
    s_nop 0
    s_mov_b32 s56, 0x3eb8aa3b
    s_mov_b32 s57, 0x3eb8aa3b
    s_mov_b32 s58, 0xa00000
    s_mov_b32 s60, 0
    s_mov_b32 s62, 36864
    s_mov_b32 s63, -110592
    s_barrier
    ds_read_b64_tr_b16 v[128:129], v6 offset:12288
    ds_read_b64_tr_b16 v[130:131], v6 offset:12800
    ds_read_b64_tr_b16 v[132:133], v6 offset:20480
    ds_read_b64_tr_b16 v[134:135], v6 offset:20992
    ds_read_b64_tr_b16 v[136:137], v6 offset:28672
    ds_read_b64_tr_b16 v[138:139], v6 offset:29184
    ds_read_b128 v[104:107], v4 offset:0
    ds_read_b128 v[108:111], v4 offset:2048
    ds_read_b128 v[112:115], v4 offset:4096
    ds_read_b128 v[116:119], v4 offset:6144
    ds_read_b128 v[120:123], v4 offset:8192
    ds_read_b128 v[124:127], v4 offset:10240
LA_loop:
    s_waitcnt lgkmcnt(5)
    v_mfma_f32_16x16x32_bf16 v[32:35], v[128:131], v[104:107], v[32:35]
    s_add_u32 s60, s60, 1
    s_and_b32 s61, s60, 3
    v_mfma_f32_16x16x32_bf16 v[56:59], v[132:135], v[104:107], v[56:59]
    s_cmp_eq_u32 s61, 0
    s_cselect_b32 s61, s63, s62
    s_waitcnt lgkmcnt(0)
    v_mfma_f32_16x16x32_bf16 v[80:83], v[104:107], v[136:139], v[80:83]
    ds_read_b64_tr_b16 v[164:165], v6 offset:16384
    ds_read_b64_tr_b16 v[166:167], v6 offset:16896
    v_mfma_f32_16x16x32_bf16 v[36:39], v[128:131], v[108:111], v[36:39]
    ds_read_b64_tr_b16 v[168:169], v6 offset:24576
    ds_read_b64_tr_b16 v[170:171], v6 offset:25088
    v_mfma_f32_16x16x32_bf16 v[60:63], v[132:135], v[108:111], v[60:63]
    ds_read_b64_tr_b16 v[172:173], v6 offset:32768
    ds_read_b64_tr_b16 v[174:175], v6 offset:33280
    v_mfma_f32_16x16x32_bf16 v[84:87], v[108:111], v[136:139], v[84:87]
    ds_read_b128 v[140:143], v5 offset:0
    v_mfma_f32_16x16x32_bf16 v[40:43], v[128:131], v[112:115], v[40:43]
    ds_read_b128 v[144:147], v5 offset:2048
    v_mfma_f32_16x16x32_bf16 v[64:67], v[132:135], v[112:115], v[64:67]
    ds_read_b128 v[148:151], v5 offset:4096
    v_mfma_f32_16x16x32_bf16 v[88:91], v[112:115], v[136:139], v[88:91]
    ds_read_b128 v[152:155], v5 offset:6144
    v_mfma_f32_16x16x32_bf16 v[44:47], v[128:131], v[116:119], v[44:47]
    ds_read_b128 v[156:159], v5 offset:8192
    v_mfma_f32_16x16x32_bf16 v[68:71], v[132:135], v[116:119], v[68:71]
    ds_read_b128 v[160:163], v5 offset:10240
    v_mfma_f32_16x16x32_bf16 v[92:95], v[116:119], v[136:139], v[92:95]
    v_mfma_f32_16x16x32_bf16 v[48:51], v[128:131], v[120:123], v[48:51]
    v_mfma_f32_16x16x32_bf16 v[72:75], v[132:135], v[120:123], v[72:75]
    v_mfma_f32_16x16x32_bf16 v[96:99], v[120:123], v[136:139], v[96:99]
    v_mfma_f32_16x16x32_bf16 v[52:55], v[128:131], v[124:127], v[52:55]
    v_mfma_f32_16x16x32_bf16 v[76:79], v[132:135], v[124:127], v[76:79]
    v_mfma_f32_16x16x32_bf16 v[100:103], v[124:127], v[136:139], v[100:103]
    s_waitcnt lgkmcnt(0)
    v_mfma_f32_16x16x32_bf16 v[32:35], v[164:167], v[140:143], v[32:35]
    v_add_u32 v4, s61, v4
    v_add_u32_e64 v6, s61, v6
    v_mfma_f32_16x16x32_bf16 v[56:59], v[168:171], v[140:143], v[56:59]
    v_add_u32_e64 v5, s61, v5
    v_mfma_f32_16x16x32_bf16 v[80:83], v[140:143], v[172:175], v[80:83]
    v_mfma_f32_16x16x32_bf16 v[36:39], v[164:167], v[144:147], v[36:39]
    v_mfma_f32_16x16x32_bf16 v[60:63], v[168:171], v[144:147], v[60:63]
    v_mfma_f32_16x16x32_bf16 v[84:87], v[144:147], v[172:175], v[84:87]
    v_mfma_f32_16x16x32_bf16 v[40:43], v[164:167], v[148:151], v[40:43]
    v_mfma_f32_16x16x32_bf16 v[64:67], v[168:171], v[148:151], v[64:67]
    s_cmp_lt_u32 s60, 7
    s_barrier
    v_mfma_f32_16x16x32_bf16 v[88:91], v[148:151], v[172:175], v[88:91]
    ds_read_b64_tr_b16 v[128:129], v6 offset:12288
    ds_read_b64_tr_b16 v[130:131], v6 offset:12800
    v_mfma_f32_16x16x32_bf16 v[44:47], v[164:167], v[152:155], v[44:47]
    ds_read_b64_tr_b16 v[132:133], v6 offset:20480
    ds_read_b64_tr_b16 v[134:135], v6 offset:20992
    v_mfma_f32_16x16x32_bf16 v[68:71], v[168:171], v[152:155], v[68:71]
    ds_read_b64_tr_b16 v[136:137], v6 offset:28672
    ds_read_b64_tr_b16 v[138:139], v6 offset:29184
    v_mfma_f32_16x16x32_bf16 v[92:95], v[152:155], v[172:175], v[92:95]
    ds_read_b128 v[104:107], v4 offset:0
    ds_read_b128 v[108:111], v4 offset:2048
    v_mfma_f32_16x16x32_bf16 v[48:51], v[164:167], v[156:159], v[48:51]
    ds_read_b128 v[112:115], v4 offset:4096
    ds_read_b128 v[116:119], v4 offset:6144
    v_mfma_f32_16x16x32_bf16 v[72:75], v[168:171], v[156:159], v[72:75]
    ds_read_b128 v[120:123], v4 offset:8192
    ds_read_b128 v[124:127], v4 offset:10240
    v_mfma_f32_16x16x32_bf16 v[96:99], v[156:159], v[172:175], v[96:99]
    v_mfma_f32_16x16x32_bf16 v[52:55], v[164:167], v[160:163], v[52:55]
    v_mfma_f32_16x16x32_bf16 v[76:79], v[168:171], v[160:163], v[76:79]
    v_mfma_f32_16x16x32_bf16 v[100:103], v[160:163], v[172:175], v[100:103]
    s_cbranch_scc1 LA_loop
    s_waitcnt lgkmcnt(0)
    v_mfma_f32_16x16x32_bf16 v[56:59], v[132:135], v[104:107], v[56:59]
    ds_read_b64_tr_b16 v[164:165], v6 offset:16384
    ds_read_b64_tr_b16 v[166:167], v6 offset:16896
    v_mfma_f32_16x16x32_bf16 v[36:39], v[128:131], v[108:111], v[36:39]
    ds_read_b64_tr_b16 v[168:169], v6 offset:24576
    ds_read_b64_tr_b16 v[170:171], v6 offset:25088
    v_mfma_f32_16x16x32_bf16 v[60:63], v[132:135], v[108:111], v[60:63]
    ds_read_b64_tr_b16 v[172:173], v6 offset:32768
    ds_read_b64_tr_b16 v[174:175], v6 offset:33280
    v_mfma_f32_16x16x32_bf16 v[32:35], v[128:131], v[104:107], v[32:35]
    ds_read_b128 v[140:143], v5 offset:0
    ds_read_b128 v[144:147], v5 offset:2048
    v_mfma_f32_16x16x32_bf16 v[40:43], v[128:131], v[112:115], v[40:43]
    ds_read_b128 v[148:151], v5 offset:4096
    ds_read_b128 v[152:155], v5 offset:6144
    v_mfma_f32_16x16x32_bf16 v[64:67], v[132:135], v[112:115], v[64:67]
    ds_read_b128 v[156:159], v5 offset:8192
    ds_read_b128 v[160:163], v5 offset:10240
    v_mfma_f32_16x16x32_bf16 v[44:47], v[128:131], v[116:119], v[44:47]
    ds_read_b64 v[22:23], v7 offset:32
    ds_read_b64 v[28:29], v7
    v_mfma_f32_16x16x32_bf16 v[68:71], v[132:135], v[116:119], v[68:71]
    v_mfma_f32_16x16x32_bf16 v[48:51], v[128:131], v[120:123], v[48:51]
    v_mfma_f32_16x16x32_bf16 v[72:75], v[132:135], v[120:123], v[72:75]
    v_mfma_f32_16x16x32_bf16 v[52:55], v[128:131], v[124:127], v[52:55]
    v_mfma_f32_16x16x32_bf16 v[76:79], v[132:135], v[124:127], v[76:79]
    v_mfma_f32_16x16x32_bf16 v[80:83], v[104:107], v[136:139], v[80:83]
    v_mfma_f32_16x16x32_bf16 v[84:87], v[108:111], v[136:139], v[84:87]
    s_waitcnt lgkmcnt(0)
    v_mfma_f32_16x16x32_bf16 v[56:59], v[168:171], v[140:143], v[56:59]
    v_readfirstlane_b32 s30, v22
    v_readfirstlane_b32 s34, v23
    s_nop 0
    v_mfma_f32_16x16x32_bf16 v[36:39], v[164:167], v[144:147], v[36:39]
    v_mfma_f32_16x16x32_bf16 v[60:63], v[168:171], v[144:147], v[60:63]
    v_mfma_f32_16x16x32_bf16 v[32:35], v[164:167], v[140:143], v[32:35]
    v_mfma_f32_16x16x32_bf16 v[40:43], v[164:167], v[148:151], v[40:43]
    v_mfma_f32_16x16x32_bf16 v[64:67], v[168:171], v[148:151], v[64:67]
    s_nop 0
    s_nop 0
    v_cvt_pk_bf16_f32 v188, v56, v57
    v_mfma_f32_16x16x32_bf16 v[44:47], v[164:167], v[152:155], v[44:47]
    v_cvt_pk_bf16_f32 v189, v58, v59
    v_cvt_pk_bf16_f32 v178, v36, v37
    v_mfma_f32_16x16x32_bf16 v[68:71], v[168:171], v[152:155], v[68:71]
    v_cvt_pk_bf16_f32 v179, v38, v39
    v_cvt_pk_bf16_f32 v190, v60, v61
    v_mfma_f32_16x16x32_bf16 v[48:51], v[164:167], v[156:159], v[48:51]
    v_cvt_pk_bf16_f32 v191, v62, v63
    v_cvt_pk_bf16_f32 v176, v32, v33
    v_mfma_f32_16x16x32_bf16 v[72:75], v[168:171], v[156:159], v[72:75]
    v_cvt_pk_bf16_f32 v177, v34, v35
    v_cvt_pk_bf16_f32 v180, v40, v41
    v_mfma_f32_16x16x32_bf16 v[52:55], v[164:167], v[160:163], v[52:55]
    v_cvt_pk_bf16_f32 v181, v42, v43
    v_cvt_pk_bf16_f32 v192, v64, v65
    v_mfma_f32_16x16x32_bf16 v[76:79], v[168:171], v[160:163], v[76:79]
    v_cvt_pk_bf16_f32 v193, v66, v67
    v_cvt_pk_bf16_f32 v182, v44, v45
    v_mfma_f32_16x16x16_bf16 v[36:39], v[190:191], v[178:179], v[8:11]
    v_cvt_pk_bf16_f32 v183, v46, v47
    v_cvt_pk_bf16_f32 v194, v68, v69
    v_mfma_f32_16x16x16_bf16 v[60:63], v[188:189], v[178:179], v[12:15]
    v_cvt_pk_bf16_f32 v195, v70, v71
    v_cvt_pk_bf16_f32 v184, v48, v49
    v_mfma_f32_16x16x16_bf16 v[32:35], v[188:189], v[176:177], v[8:11]
    v_cvt_pk_bf16_f32 v185, v50, v51
    v_cvt_pk_bf16_f32 v196, v72, v73
    v_mfma_f32_16x16x16_bf16 v[40:43], v[192:193], v[180:181], v[8:11]
    v_cvt_pk_bf16_f32 v197, v74, v75
    v_cvt_pk_bf16_f32 v186, v52, v53
    v_mfma_f32_16x16x16_bf16 v[64:67], v[190:191], v[180:181], v[12:15]
    v_cvt_pk_bf16_f32 v187, v54, v55
    v_cvt_pk_bf16_f32 v198, v76, v77
    v_mfma_f32_16x16x16_bf16 v[44:47], v[194:195], v[182:183], v[8:11]
    v_cvt_pk_bf16_f32 v199, v78, v79
    v_max_f32_e64 v36, v36, v60
    v_mfma_f32_16x16x16_bf16 v[68:71], v[192:193], v[182:183], v[12:15]
    v_max_f32 v37, v37, v61
    v_max_f32 v38, v38, v62
    v_mfma_f32_16x16x16_bf16 v[48:51], v[196:197], v[184:185], v[8:11]
    v_cvt_pk_bf16_f32 v32, 0, v32
    v_cvt_pk_bf16_f32 v33, 0, v33
    v_mfma_f32_16x16x16_bf16 v[72:75], v[194:195], v[184:185], v[12:15]
    v_cvt_pk_bf16_f32 v34, 0, v34
    v_cvt_pk_bf16_f32 v36, 0, v36
    v_mfma_f32_16x16x16_bf16 v[52:55], v[198:199], v[186:187], v[8:11]
    v_cvt_pk_bf16_f32 v37, 0, v37
    v_cvt_pk_bf16_f32 v38, 0, v38
    v_mfma_f32_16x16x16_bf16 v[76:79], v[196:197], v[186:187], v[12:15]
    v_max_f32_e64 v39, v39, v63
    v_cvt_pk_bf16_f32 v35, 0, v35
    v_mfma_f32_16x16x32_bf16 v[88:91], v[112:115], v[136:139], v[88:91]
    v_max3_f32 v236, v32, v33, v34
    v_cvt_pk_bf16_f32 v39, 0, v39
    v_mfma_f32_16x16x32_bf16 v[92:95], v[116:119], v[136:139], v[92:95]
    v_max3_f32 v237, v36, v37, v38
    v_max_f32_e64 v236, v236, v35
    v_mfma_f32_16x16x32_bf16 v[80:83], v[140:143], v[172:175], v[80:83]
    v_max_f32 v237, v237, v39
    v_max_f32 v40, v40, v64
    v_mfma_f32_16x16x32_bf16 v[84:87], v[144:147], v[172:175], v[84:87]
    v_max_f32 v41, v41, v65
    v_max_f32 v42, v42, v66
    v_mfma_f32_16x16x32_bf16 v[96:99], v[120:123], v[136:139], v[96:99]
    v_max_f32 v44, v44, v68
    v_max_f32 v45, v45, v69
    v_mfma_f32_16x16x32_bf16 v[100:103], v[124:127], v[136:139], v[100:103]
    v_max_f32_e64 v46, v46, v70
    v_cvt_pk_bf16_f32 v40, 0, v40
    v_mfma_f32_16x16x32_bf16 v[88:91], v[148:151], v[172:175], v[88:91]
    v_cvt_pk_bf16_f32 v41, 0, v41
    v_cvt_pk_bf16_f32 v42, 0, v42
    v_mfma_f32_16x16x32_bf16 v[92:95], v[152:155], v[172:175], v[92:95]
    v_cvt_pk_bf16_f32 v44, 0, v44
    v_cvt_pk_bf16_f32 v45, 0, v45
    v_mfma_f32_16x16x32_bf16 v[96:99], v[156:159], v[172:175], v[96:99]
    v_cvt_pk_bf16_f32 v46, 0, v46
    v_max_f32_e64 v43, v43, v67
    v_mfma_f32_16x16x32_bf16 v[100:103], v[160:163], v[172:175], v[100:103]
    v_max_f32_e64 v47, v47, v71
    v_cvt_pk_bf16_f32 v43, 0, v43
    v_max3_f32 v240, v40, v41, v42
    v_cvt_pk_bf16_f32 v47, 0, v47
    v_max3_f32 v241, v44, v45, v46
    v_permlane32_swap_b32 v236, v237
    v_max_f32 v240, v240, v43
    v_max_f32 v241, v241, v47
    v_max_f32 v48, v48, v72
    v_max_f32 v49, v49, v73
    v_max_f32 v50, v50, v74
    v_max_f32 v52, v52, v76
    v_max_f32 v53, v53, v77
    v_max_f32 v54, v54, v78
    v_max_f32 v236, v236, v237
    v_cvt_pk_bf16_f32 v48, 0, v48
    v_cvt_pk_bf16_f32 v49, 0, v49
    v_cvt_pk_bf16_f32 v50, 0, v50
    v_cvt_pk_bf16_f32 v52, 0, v52
    v_cvt_pk_bf16_f32 v53, 0, v53
    v_cvt_pk_bf16_f32 v54, 0, v54
    v_max_f32 v51, v51, v75
    v_max_f32 v55, v55, v79
    v_mov_b32_e64 v237, v236
    v_cvt_pk_bf16_f32 v51, 0, v51
    v_max3_f32 v244, v48, v49, v50
    v_cvt_pk_bf16_f32 v55, 0, v55
    v_max3_f32 v245, v52, v53, v54
    v_permlane32_swap_b32 v240, v241
    v_max_f32 v244, v244, v51
    v_max_f32 v245, v245, v55
    v_permlane16_swap_b32 v236, v237
    v_max_f32 v240, v240, v241
    v_mov_b32 v241, v240
    v_max_f32 v236, v236, v237
    v_permlane32_swap_b32 v244, v245
    v_mul_f32 v238, s56, v236
    v_mul_f32 v239, s56, v236
    v_permlane16_swap_b32 v240, v241
    v_max_f32 v244, v244, v245
    v_mov_b32 v245, v244
    v_permlane32_swap_b32 v238, v239
    v_max_f32 v240, v240, v241
    v_mul_f32 v242, s56, v240
    v_mul_f32 v243, s56, v240
    v_permlane16_swap_b32 v244, v245
    v_pk_fma_f32 v[36:37], v[36:37], s[56:57], v[238:239] op_sel:[0,0,1] op_sel_hi:[1,1,1] neg_lo:[0,0,1] neg_hi:[0,0,1]
    v_pk_fma_f32 v[38:39], v[38:39], s[56:57], v[238:239] op_sel:[0,0,1] op_sel_hi:[1,1,1] neg_lo:[0,0,1] neg_hi:[0,0,1]
    v_exp_f32 v36, v36
    v_exp_f32 v37, v37
    v_exp_f32 v38, v38
    v_exp_f32 v39, v39
    v_permlane32_swap_b32 v242, v243
    v_max_f32 v244, v244, v245
    v_pk_fma_f32 v[32:33], v[32:33], s[56:57], v[238:239] op_sel:[0,0,0] op_sel_hi:[1,1,0] neg_lo:[0,0,1] neg_hi:[0,0,1]
    v_pk_fma_f32 v[34:35], v[34:35], s[56:57], v[238:239] op_sel:[0,0,0] op_sel_hi:[1,1,0] neg_lo:[0,0,1] neg_hi:[0,0,1]
    v_mul_f32 v246, s56, v244
    v_mul_f32 v247, s56, v244
    v_exp_f32 v32, v32
    v_exp_f32 v33, v33
    v_exp_f32 v34, v34
    v_exp_f32 v35, v35
    v_pk_fma_f32 v[40:41], v[40:41], s[56:57], v[242:243] op_sel:[0,0,0] op_sel_hi:[1,1,0] neg_lo:[0,0,1] neg_hi:[0,0,1]
    v_pk_fma_f32 v[42:43], v[42:43], s[56:57], v[242:243] op_sel:[0,0,0] op_sel_hi:[1,1,0] neg_lo:[0,0,1] neg_hi:[0,0,1]
    v_pk_fma_f32 v[44:45], v[44:45], s[56:57], v[242:243] op_sel:[0,0,1] op_sel_hi:[1,1,1] neg_lo:[0,0,1] neg_hi:[0,0,1]
    v_pk_fma_f32 v[46:47], v[46:47], s[56:57], v[242:243] op_sel:[0,0,1] op_sel_hi:[1,1,1] neg_lo:[0,0,1] neg_hi:[0,0,1]
    v_cvt_pk_bf16_f32 v218, v36, v37
    v_cvt_pk_bf16_f32 v219, v38, v39
    v_exp_f32 v40, v40
    v_exp_f32 v41, v41
    v_mfma_f32_16x16x16_bf16 v[60:63], v[20:21], v[218:219], 0
    v_exp_f32 v42, v42
    v_exp_f32 v43, v43
    v_exp_f32 v44, v44
    v_exp_f32 v45, v45
    v_exp_f32_e64 v46, v46
    v_exp_f32 v47, v47
    v_permlane32_swap_b32 v246, v247
    v_cvt_pk_bf16_f32 v214, v32, v33
    v_cvt_pk_bf16_f32 v215, v34, v35
    v_pk_fma_f32 v[48:49], v[48:49], s[56:57], v[246:247] op_sel:[0,0,0] op_sel_hi:[1,1,0] neg_lo:[0,0,1] neg_hi:[0,0,1]
    v_pk_fma_f32 v[50:51], v[50:51], s[56:57], v[246:247] op_sel:[0,0,0] op_sel_hi:[1,1,0] neg_lo:[0,0,1] neg_hi:[0,0,1]
    v_pk_fma_f32 v[52:53], v[52:53], s[56:57], v[246:247] op_sel:[0,0,1] op_sel_hi:[1,1,1] neg_lo:[0,0,1] neg_hi:[0,0,1]
    v_pk_fma_f32 v[54:55], v[54:55], s[56:57], v[246:247] op_sel:[0,0,1] op_sel_hi:[1,1,1] neg_lo:[0,0,1] neg_hi:[0,0,1]
    v_cvt_pk_bf16_f32 v222, v40, v41
    v_cvt_pk_bf16_f32 v223, v42, v43
    v_cvt_pk_bf16_f32 v226, v44, v45
    v_mfma_f32_16x16x16_bf16 v[56:59], v[20:21], v[214:215], 0
    v_cvt_pk_bf16_f32 v227, v46, v47
    v_and_b32_e64 v216, v18, v218
    v_mfma_f32_16x16x16_bf16 v[64:67], v[20:21], v[222:223], 0
    v_and_b32_e64 v217, v19, v219
    v_cvt_pk_bf16_f32 v200, v80, v81
    v_mfma_f32_16x16x16_bf16 v[68:71], v[20:21], v[226:227], 0
    v_cvt_pk_bf16_f32 v201, v82, v83
    v_cvt_pk_bf16_f32 v202, v84, v85
    v_cvt_pk_bf16_f32 v203, v86, v87
    v_mfma_f32_16x16x16_bf16 v[80:83], v[200:201], v[214:215], 0
    v_exp_f32 v48, v48
    v_exp_f32 v49, v49
    v_exp_f32 v50, v50
    v_exp_f32 v51, v51
    v_exp_f32 v52, v52
    v_exp_f32 v53, v53
    v_exp_f32 v54, v54
    v_exp_f32 v55, v55
    v_and_b32 v218, v16, v218
    v_and_b32 v219, v17, v219
    v_cvt_pk_bf16_f32 v230, v48, v49
    v_cvt_pk_bf16_f32 v231, v50, v51
    v_mfma_f32_16x16x32_bf16 v[84:87], v[200:203], v[216:219], 0
    v_cvt_pk_bf16_f32 v234, v52, v53
    v_cvt_pk_bf16_f32 v235, v54, v55
    v_mfma_f32_16x16x16_bf16 v[72:75], v[20:21], v[230:231], 0
    v_and_b32 v220, v18, v222
    v_and_b32 v221, v19, v223
    v_mfma_f32_16x16x16_bf16 v[76:79], v[20:21], v[234:235], 0
    v_and_b32 v224, v18, v226
    v_and_b32 v225, v19, v227
    v_cvt_pk_bf16_f32 v204, v88, v89
    v_cvt_pk_bf16_f32 v205, v90, v91
    v_cvt_pk_bf16_f32 v206, v92, v93
    v_cvt_pk_bf16_f32 v207, v94, v95
    v_and_b32 v222, v16, v222
    v_and_b32 v223, v17, v223
    v_and_b32 v226, v16, v226
    v_and_b32 v227, v17, v227
    v_mfma_f32_16x16x32_bf16 v[88:91], v[202:205], v[220:223], 0
    v_and_b32 v228, v18, v230
    v_and_b32 v229, v19, v231
    v_mfma_f32_16x16x32_bf16 v[92:95], v[204:207], v[224:227], 0
    v_and_b32 v232, v18, v234
    v_and_b32 v233, v19, v235
    v_cvt_pk_bf16_f32 v208, v96, v97
    v_cvt_pk_bf16_f32 v209, v98, v99
    v_cvt_pk_bf16_f32 v210, v100, v101
    v_cvt_pk_bf16_f32 v211, v102, v103
    v_and_b32 v230, v16, v230
    v_and_b32 v231, v17, v231
    v_and_b32 v234, v16, v234
    v_and_b32 v235, v17, v235
    v_mfma_f32_16x16x32_bf16 v[96:99], v[206:209], v[228:231], 0
    v_rcp_f32_e64 v56, v56
    v_mfma_f32_16x16x32_bf16 v[100:103], v[208:211], v[232:235], 0
    v_rcp_f32_e64 v60, v60
    v_pk_mul_f32 v[80:81], v[80:81], v[56:57] op_sel_hi:[1,0]
    v_pk_mul_f32 v[82:83], v[82:83], v[56:57] op_sel_hi:[1,0]
    v_pk_mul_f32 v[84:85], v[84:85], v[60:61] op_sel_hi:[1,0]
    v_pk_mul_f32 v[86:87], v[86:87], v[60:61] op_sel_hi:[1,0]
    v_cvt_pk_bf16_f32 v32, v80, v81
    v_cvt_pk_bf16_f32 v33, v82, v83
    v_cvt_pk_bf16_f32 v34, v84, v85
    v_cvt_pk_bf16_f32 v35, v86, v87
    v_rcp_f32 v64, v64
    v_rcp_f32 v68, v68
    v_pk_mul_f32 v[88:89], v[88:89], v[64:65] op_sel_hi:[1,0]
    v_pk_mul_f32 v[90:91], v[90:91], v[64:65] op_sel_hi:[1,0]
    v_pk_mul_f32 v[92:93], v[92:93], v[68:69] op_sel_hi:[1,0]
    v_pk_mul_f32 v[94:95], v[94:95], v[68:69] op_sel_hi:[1,0]
    v_permlane16_swap_b32 v32, v34
    v_permlane16_swap_b32 v33, v35
    v_cvt_pk_bf16_f32 v40, v88, v89
    v_cvt_pk_bf16_f32 v41, v90, v91
    v_cvt_pk_bf16_f32 v42, v92, v93
    v_cvt_pk_bf16_f32 v43, v94, v95
    v_rcp_f32 v72, v72
    v_rcp_f32 v76, v76
    buffer_store_dwordx4 v[32:35], v27, s[28:31], s58 offen
    v_pk_mul_f32 v[96:97], v[96:97], v[72:73] op_sel_hi:[1,0]
    v_pk_mul_f32 v[98:99], v[98:99], v[72:73] op_sel_hi:[1,0]
    v_pk_mul_f32 v[100:101], v[100:101], v[76:77] op_sel_hi:[1,0]
    v_pk_mul_f32 v[102:103], v[102:103], v[76:77] op_sel_hi:[1,0]
    buffer_store_dwordx4 v[32:35], v27, s[32:35], 0 offen sc1
    v_permlane16_swap_b32 v40, v42
    v_permlane16_swap_b32 v41, v43
    v_cvt_pk_bf16_f32 v48, v96, v97
    v_cvt_pk_bf16_f32 v49, v98, v99
    v_cvt_pk_bf16_f32 v50, v100, v101
    v_cvt_pk_bf16_f32 v51, v102, v103
    buffer_store_dwordx4 v[40:43], v26, s[28:31], s58 offen
    buffer_store_dwordx4 v[40:43], v26, s[32:35], 0 offen sc1
    v_permlane16_swap_b32 v48, v50
    v_permlane16_swap_b32 v49, v51
    buffer_store_dwordx4 v[48:51], v25, s[28:31], s58 offen
    buffer_store_dwordx4 v[48:51], v25, s[32:35], 0 offen sc1
    s_mov_b64 exec, 1
    s_waitcnt vmcnt(0)
    buffer_store_dwordx2 v[28:29], v0, s[28:31], s73 offen
    buffer_store_dwordx2 v[28:29], v0, s[32:35], s73 offen sc1
    s_mov_b64 exec, -1
    s_lshr_b32 s49, s48, 1
    s_mul_i32 s49, s49, s45
    s_cmp_lg_u32 s49, 0
    s_cbranch_scc1 LH_end
    ds_read_b32 v23, v7 offset:40
    v_mov_b32 v19, v7
    v_mov_b32 v14, v253
    v_xor_b32 v15, 32, v253
    v_xor_b32_e64 v16, 64, v253
    v_xor_b32 v17, 96, v253
    s_mov_b32 s49, 0
LHs_watch:
    ds_read_b32 v20, v19 offset:20
    s_add_u32 s49, s49, 1
    s_waitcnt lgkmcnt(0)
    v_readfirstlane_b32 s51, v20
    s_nop 0
    s_cmp_ge_u32 s51, 4
    s_cbranch_scc1 LHs_seen
    s_cmp_lt_u32 s49, 0x80000
    s_cbranch_scc1 LHs_watch
LHs_seen:
    ds_read_b64_tr_b16 v[80:81], v14 offset:0
    ds_read_b64_tr_b16 v[82:83], v14 offset:512
    ds_read_b64_tr_b16 v[84:85], v15 offset:0
    ds_read_b64_tr_b16 v[86:87], v15 offset:512
    ds_read_b64_tr_b16 v[88:89], v16 offset:0
    ds_read_b64_tr_b16 v[90:91], v16 offset:512
    ds_read_b64_tr_b16 v[92:93], v17 offset:0
    ds_read_b64_tr_b16 v[94:95], v17 offset:512
    ds_read_b64_tr_b16 v[96:97], v14 offset:4096
    ds_read_b64_tr_b16 v[98:99], v14 offset:4608
    ds_read_b64_tr_b16 v[100:101], v15 offset:4096
    ds_read_b64_tr_b16 v[102:103], v15 offset:4608
    ds_read_b64_tr_b16 v[104:105], v16 offset:4096
    ds_read_b64_tr_b16 v[106:107], v16 offset:4608
    ds_read_b64_tr_b16 v[108:109], v17 offset:4096
    ds_read_b64_tr_b16 v[110:111], v17 offset:4608
    ds_read_b64_tr_b16 v[112:113], v14 offset:8192
    ds_read_b64_tr_b16 v[114:115], v14 offset:8704
    ds_read_b64_tr_b16 v[116:117], v15 offset:8192
    ds_read_b64_tr_b16 v[118:119], v15 offset:8704
    ds_read_b64_tr_b16 v[120:121], v16 offset:8192
    ds_read_b64_tr_b16 v[122:123], v16 offset:8704
    ds_read_b64_tr_b16 v[124:125], v17 offset:8192
    ds_read_b64_tr_b16 v[126:127], v17 offset:8704
    ds_read_b64_tr_b16 v[128:129], v14 offset:12288
    ds_read_b64_tr_b16 v[130:131], v14 offset:12800
    ds_read_b64_tr_b16 v[132:133], v15 offset:12288
    ds_read_b64_tr_b16 v[134:135], v15 offset:12800
    ds_read_b64_tr_b16 v[136:137], v16 offset:12288
    ds_read_b64_tr_b16 v[138:139], v16 offset:12800
    ds_read_b64_tr_b16 v[140:141], v17 offset:12288
    ds_read_b64_tr_b16 v[142:143], v17 offset:12800
    ds_read_b64_tr_b16 v[144:145], v14 offset:16384
    ds_read_b64_tr_b16 v[146:147], v14 offset:16896
    ds_read_b64_tr_b16 v[148:149], v15 offset:16384
    ds_read_b64_tr_b16 v[150:151], v15 offset:16896
    ds_read_b64_tr_b16 v[152:153], v16 offset:16384
    ds_read_b64_tr_b16 v[154:155], v16 offset:16896
    ds_read_b64_tr_b16 v[156:157], v17 offset:16384
    ds_read_b64_tr_b16 v[158:159], v17 offset:16896
    ds_read_b64_tr_b16 v[160:161], v14 offset:20480
    ds_read_b64_tr_b16 v[162:163], v14 offset:20992
    ds_read_b64_tr_b16 v[164:165], v15 offset:20480
    ds_read_b64_tr_b16 v[166:167], v15 offset:20992
    ds_read_b64_tr_b16 v[168:169], v16 offset:20480
    ds_read_b64_tr_b16 v[170:171], v16 offset:20992
    ds_read_b64_tr_b16 v[172:173], v17 offset:20480
    ds_read_b64_tr_b16 v[174:175], v17 offset:20992
    ds_read_b64_tr_b16 v[176:177], v14 offset:24576
    ds_read_b64_tr_b16 v[178:179], v14 offset:25088
    ds_read_b64_tr_b16 v[180:181], v15 offset:24576
    ds_read_b64_tr_b16 v[182:183], v15 offset:25088
    ds_read_b64_tr_b16 v[184:185], v16 offset:24576
    ds_read_b64_tr_b16 v[186:187], v16 offset:25088
    ds_read_b64_tr_b16 v[188:189], v17 offset:24576
    ds_read_b64_tr_b16 v[190:191], v17 offset:25088
    ds_read_b64_tr_b16 v[192:193], v14 offset:28672
    ds_read_b64_tr_b16 v[194:195], v14 offset:29184
    ds_read_b64_tr_b16 v[196:197], v15 offset:28672
    ds_read_b64_tr_b16 v[198:199], v15 offset:29184
    ds_read_b64_tr_b16 v[200:201], v16 offset:28672
    ds_read_b64_tr_b16 v[202:203], v16 offset:29184
    ds_read_b64_tr_b16 v[204:205], v17 offset:28672
    ds_read_b64_tr_b16 v[206:207], v17 offset:29184
    v_add_u32_e64 v30, v23, v30
    s_lshr_b32 s50, s48, 1
    s_lshl_b32 s51, s50, 12
    s_add_u32 s51, s51, 83968
    v_lshl_add_u32 v8, v0, 4, s51
    s_lshl_b32 s50, s50, 2
    v_add_u32_e64 v19, s50, v7
    s_mov_b32 s49, 0
LH_poll:
    buffer_load_dwordx2 v[20:21], v252, s[40:43], 0 offen sc1
    s_add_u32 s49, s49, 1
    s_waitcnt vmcnt(0)
    v_cmp_ne_u64 vcc, v[28:29], v[20:21]
    s_nop 4
    s_cbranch_vccz LH_go
    s_cmp_lt_u32 s49, 0x8000
    s_cbranch_scc1 LH_poll
LH_go:
    s_setprio 3
    s_nop 0
    s_and_b32 s93, s93, 0xffff
    buffer_load_dwordx4 v[32:35], v30, s[40:43], s93 offen sc1
    s_add_u32 s93, s93, 0x1000
    s_and_b32 s93, s93, 0xffff
    buffer_load_dwordx4 v[36:39], v30, s[40:43], s93 offen sc1
    s_add_u32 s93, s93, 0x1000
    s_and_b32 s93, s93, 0xffff
    buffer_load_dwordx4 v[40:43], v30, s[40:43], s93 offen sc1
    s_add_u32 s93, s93, 0x1000
    s_and_b32 s93, s93, 0xffff
    buffer_load_dwordx4 v[44:47], v30, s[40:43], s93 offen sc1
    s_add_u32 s93, s93, 0x1000
    s_and_b32 s93, s93, 0xffff
    buffer_load_dwordx4 v[48:51], v30, s[40:43], s93 offen sc1
    s_add_u32 s93, s93, 0x1000
    s_and_b32 s93, s93, 0xffff
    buffer_load_dwordx4 v[52:55], v30, s[40:43], s93 offen sc1
    s_add_u32 s93, s93, 0x1000
    s_and_b32 s93, s93, 0xffff
    buffer_load_dwordx4 v[56:59], v30, s[40:43], s93 offen sc1
    s_add_u32 s93, s93, 0x1000
    s_and_b32 s93, s93, 0xffff
    buffer_load_dwordx4 v[60:63], v30, s[40:43], s93 offen sc1
    s_add_u32 s93, s93, 0x1000
    s_waitcnt vmcnt(7) lgkmcnt(0)
    s_nop 0
    v_mfma_f32_16x16x32_bf16 v[64:67], v[80:83], v[32:35], 0
    v_mfma_f32_16x16x32_bf16 v[68:71], v[84:87], v[32:35], 0
    v_mfma_f32_16x16x32_bf16 v[72:75], v[88:91], v[32:35], 0
    v_mfma_f32_16x16x32_bf16 v[76:79], v[92:95], v[32:35], 0
    s_waitcnt vmcnt(6)
    s_nop 0
    v_mfma_f32_16x16x32_bf16 v[64:67], v[96:99], v[36:39], v[64:67]
    v_mfma_f32_16x16x32_bf16 v[68:71], v[100:103], v[36:39], v[68:71]
    v_mfma_f32_16x16x32_bf16 v[72:75], v[104:107], v[36:39], v[72:75]
    v_mfma_f32_16x16x32_bf16 v[76:79], v[108:111], v[36:39], v[76:79]
    s_waitcnt vmcnt(5)
    s_nop 0
    v_mfma_f32_16x16x32_bf16 v[64:67], v[112:115], v[40:43], v[64:67]
    v_mfma_f32_16x16x32_bf16 v[68:71], v[116:119], v[40:43], v[68:71]
    v_mfma_f32_16x16x32_bf16 v[72:75], v[120:123], v[40:43], v[72:75]
    v_mfma_f32_16x16x32_bf16 v[76:79], v[124:127], v[40:43], v[76:79]
    s_waitcnt vmcnt(4)
    s_nop 0
    v_mfma_f32_16x16x32_bf16 v[64:67], v[128:131], v[44:47], v[64:67]
    v_mfma_f32_16x16x32_bf16 v[68:71], v[132:135], v[44:47], v[68:71]
    v_mfma_f32_16x16x32_bf16 v[72:75], v[136:139], v[44:47], v[72:75]
    v_mfma_f32_16x16x32_bf16 v[76:79], v[140:143], v[44:47], v[76:79]
    s_waitcnt vmcnt(3)
    s_nop 0
    v_mfma_f32_16x16x32_bf16 v[64:67], v[144:147], v[48:51], v[64:67]
    v_mfma_f32_16x16x32_bf16 v[68:71], v[148:151], v[48:51], v[68:71]
    v_mfma_f32_16x16x32_bf16 v[72:75], v[152:155], v[48:51], v[72:75]
    v_mfma_f32_16x16x32_bf16 v[76:79], v[156:159], v[48:51], v[76:79]
    s_waitcnt vmcnt(2)
    s_nop 0
    v_mfma_f32_16x16x32_bf16 v[64:67], v[160:163], v[52:55], v[64:67]
    v_mfma_f32_16x16x32_bf16 v[68:71], v[164:167], v[52:55], v[68:71]
    v_mfma_f32_16x16x32_bf16 v[72:75], v[168:171], v[52:55], v[72:75]
    v_mfma_f32_16x16x32_bf16 v[76:79], v[172:175], v[52:55], v[76:79]
    s_waitcnt vmcnt(1)
    s_nop 0
    v_mfma_f32_16x16x32_bf16 v[64:67], v[176:179], v[56:59], v[64:67]
    v_mfma_f32_16x16x32_bf16 v[68:71], v[180:183], v[56:59], v[68:71]
    v_mfma_f32_16x16x32_bf16 v[72:75], v[184:187], v[56:59], v[72:75]
    v_mfma_f32_16x16x32_bf16 v[76:79], v[188:191], v[56:59], v[76:79]
    s_waitcnt vmcnt(0)
    s_nop 0
    v_mfma_f32_16x16x32_bf16 v[64:67], v[192:195], v[60:63], v[64:67]
    v_mfma_f32_16x16x32_bf16 v[68:71], v[196:199], v[60:63], v[68:71]
    v_mfma_f32_16x16x32_bf16 v[72:75], v[200:203], v[60:63], v[72:75]
    v_mfma_f32_16x16x32_bf16 v[76:79], v[204:207], v[60:63], v[76:79]
    s_bitcmp1_b32 s48, 0
    s_cbranch_scc0 LH_sum
    s_nop 2
    s_nop 0
    ds_write_b128 v8, v[64:67] offset:0
    ds_write_b128 v8, v[68:71] offset:1024
    ds_write_b128 v8, v[72:75] offset:2048
    ds_write_b128 v8, v[76:79] offset:3072
    ds_write_b32 v19, v19 offset:12
    s_branch LH_end
LH_sum:
    s_mov_b32 s49, 0
LHp_watch:
    ds_read_b32 v20, v19 offset:12
    s_add_u32 s49, s49, 1
    s_waitcnt lgkmcnt(0)
    v_readfirstlane_b32 s51, v20
    s_nop 0
    s_cmp_ge_u32 s51, 1
    s_cbranch_scc1 LHp_seen
    s_cmp_lt_u32 s49, 0x80000
    s_cbranch_scc1 LHp_watch
    s_nop 0
LHp_seen:
    ds_read_b128 v[208:211], v8 offset:0
    ds_read_b128 v[212:215], v8 offset:1024
    ds_read_b128 v[216:219], v8 offset:2048
    ds_read_b128 v[220:223], v8 offset:3072
    s_waitcnt lgkmcnt(3)
    v_add_f32 v64, v64, v208
    v_add_f32 v65, v65, v209
    v_add_f32 v66, v66, v210
    v_add_f32 v67, v67, v211
    s_waitcnt lgkmcnt(2)
    v_add_f32 v68, v68, v212
    v_add_f32 v69, v69, v213
    v_add_f32 v70, v70, v214
    v_add_f32 v71, v71, v215
    s_waitcnt lgkmcnt(1)
    v_add_f32 v72, v72, v216
    v_add_f32 v73, v73, v217
    v_add_f32 v74, v74, v218
    v_add_f32 v75, v75, v219
    s_waitcnt lgkmcnt(0)
    v_add_f32 v76, v76, v220
    v_add_f32 v77, v77, v221
    v_add_f32 v78, v78, v222
    v_add_f32 v79, v79, v223
    v_cvt_pk_bf16_f32 v64, v64, v65
    v_cvt_pk_bf16_f32 v65, v66, v67
    ds_write_b64 v254, v[64:65] offset:0
    v_cvt_pk_bf16_f32 v68, v68, v69
    v_cvt_pk_bf16_f32 v69, v70, v71
    ds_write_b64 v254, v[68:69] offset:32
    v_cvt_pk_bf16_f32 v72, v72, v73
    v_cvt_pk_bf16_f32 v73, v74, v75
    ds_write_b64 v254, v[72:73] offset:64
    v_cvt_pk_bf16_f32 v76, v76, v77
    v_cvt_pk_bf16_f32 v77, v78, v79
    ds_write_b64 v254, v[76:77] offset:96
    ds_read_b128 v[32:35], v255 offset:0
    ds_read_b128 v[36:39], v255 offset:1152
    s_mov_b32 s54, 0x8000
    s_waitcnt lgkmcnt(1)
    buffer_store_dwordx4 v[32:35], v31, s[88:91], 0 offen sc1
    s_waitcnt lgkmcnt(0)
    buffer_store_dwordx4 v[36:39], v31, s[88:91], s54 offen sc1
LH_end:
    s_endpgm
L_Bcomp:
    s_setprio 1
    s_and_b32 s46, s3, 3
    v_lshrrev_b32 v7, 2, v4
    v_and_b32_e64 v8, 3, v4
    v_lshl_add_u32 v9, v5, 3, v7
    v_lshlrev_b32_e64 v9, 10, v9
    v_lshl_add_u32 v9, v8, 8, v9
    v_lshl_add_u32 v7, v8, 2, v7
    s_lshr_b32 s49, s46, 1
    v_xor_b32 v7, s49, v7
    v_lshl_add_u32 v9, v7, 4, v9
    s_and_b32 s49, s46, 1
    s_lshl_b32 s49, s49, 3
    s_add_u32 s49, s49, 69632
    v_add_u32 v8, s49, v9
    v_xor_b32 v9, 32, v8
    v_xor_b32_e64 v10, 64, v8
    v_xor_b32 v11, 96, v8
    v_xor_b32 v12, 128, v8
    v_xor_b32 v13, 160, v8
    v_xor_b32 v14, 192, v8
    v_xor_b32 v15, 224, v8
    v_lshlrev_b32_e64 v21, 6, v4
    v_lshl_add_u32 v21, v5, 4, v21
    v_add_u32 v16, 143360, v21
    v_mul_u32_u24 v20, 2064, v4
    v_lshl_add_u32 v20, v5, 8, v20
    s_lshl_b32 s49, s46, 4
    s_add_u32 s49, s49, 102400
    v_add_u32 v20, s49, v20
    v_lshlrev_b32 v6, 2, v5
    v_cvt_f32_u32 v6, v6
    s_lshl_b32 s50, s46, 2
    v_cvt_f32_u32 v7, s50
    v_add_f32_e64 v24, 0, v7
    v_mul_f32 v24, 0xbb000000, v24
    v_add_f32_e64 v25, 1.0, v7
    v_mul_f32 v25, 0xbb000000, v25
    v_add_f32_e64 v26, 2.0, v7
    v_mul_f32 v26, 0xbb000000, v26
    v_add_f32 v27, 0x40400000, v7
    v_mul_f32 v27, 0xbb000000, v27
    v_add_f32 v7, 0x0, v6
    v_mul_f32 v28, v7, v24
    v_mul_f32 v29, v7, v25
    v_mul_f32 v30, v7, v26
    v_mul_f32 v31, v7, v27
    v_cos_f32 v160, v28
    v_sin_f32 v192, v28
    v_cos_f32 v164, v29
    v_sin_f32 v196, v29
    v_cos_f32 v168, v30
    v_sin_f32 v200, v30
    v_cos_f32 v172, v31
    v_sin_f32 v204, v31
    v_add_f32 v7, 0x3f800000, v6
    v_mul_f32 v28, v7, v24
    v_mul_f32 v29, v7, v25
    v_mul_f32 v30, v7, v26
    v_mul_f32 v31, v7, v27
    v_cos_f32 v161, v28
    v_sin_f32 v193, v28
    v_cos_f32 v165, v29
    v_sin_f32 v197, v29
    v_cos_f32 v169, v30
    v_sin_f32 v201, v30
    v_cos_f32 v173, v31
    v_sin_f32 v205, v31
    v_add_f32 v7, 0x40000000, v6
    v_mul_f32 v28, v7, v24
    v_mul_f32 v29, v7, v25
    v_mul_f32 v30, v7, v26
    v_mul_f32 v31, v7, v27
    v_cos_f32 v162, v28
    v_sin_f32 v194, v28
    v_cos_f32 v166, v29
    v_sin_f32 v198, v29
    v_cos_f32 v170, v30
    v_sin_f32 v202, v30
    v_cos_f32 v174, v31
    v_sin_f32_e64 v206, v31
    v_add_f32 v7, 0x40400000, v6
    v_mul_f32 v28, v7, v24
    v_mul_f32 v29, v7, v25
    v_mul_f32 v30, v7, v26
    v_mul_f32 v31, v7, v27
    v_cos_f32 v163, v28
    v_sin_f32 v195, v28
    v_cos_f32 v167, v29
    v_sin_f32 v199, v29
    v_cos_f32 v171, v30
    v_sin_f32 v203, v30
    v_cos_f32 v175, v31
    v_sin_f32 v207, v31
    v_add_f32 v7, 0x41800000, v6
    v_mul_f32 v28, v7, v24
    v_mul_f32 v29, v7, v25
    v_mul_f32 v30, v7, v26
    v_mul_f32 v31, v7, v27
    v_cos_f32 v176, v28
    v_sin_f32 v208, v28
    v_cos_f32 v180, v29
    v_sin_f32 v212, v29
    v_cos_f32 v184, v30
    v_sin_f32 v216, v30
    v_cos_f32 v188, v31
    v_sin_f32 v220, v31
    v_add_f32 v7, 0x41880000, v6
    v_mul_f32 v28, v7, v24
    v_mul_f32 v29, v7, v25
    v_mul_f32 v30, v7, v26
    v_mul_f32 v31, v7, v27
    v_cos_f32 v177, v28
    v_sin_f32 v209, v28
    v_cos_f32 v181, v29
    v_sin_f32 v213, v29
    v_cos_f32 v185, v30
    v_sin_f32 v217, v30
    v_cos_f32 v189, v31
    v_sin_f32 v221, v31
    v_add_f32 v7, 0x41900000, v6
    v_mul_f32 v28, v7, v24
    v_mul_f32 v29, v7, v25
    v_mul_f32 v30, v7, v26
    v_mul_f32 v31, v7, v27
    v_cos_f32 v178, v28
    v_sin_f32 v210, v28
    v_cos_f32 v182, v29
    v_sin_f32 v214, v29
    v_cos_f32 v186, v30
    v_sin_f32 v218, v30
    v_cos_f32 v190, v31
    v_sin_f32 v222, v31
    v_add_f32 v7, 0x41980000, v6
    v_mul_f32 v28, v7, v24
    v_mul_f32 v29, v7, v25
    v_mul_f32 v30, v7, v26
    v_mul_f32 v31, v7, v27
    v_cos_f32 v179, v28
    v_sin_f32 v211, v28
    v_cos_f32 v183, v29
    v_sin_f32 v215, v29
    v_cos_f32 v187, v30
    v_sin_f32 v219, v30
    v_cos_f32 v191, v31
    v_sin_f32 v223, v31
    s_mov_b32 s58, 0x80008000
    s_mov_b32 s56, 0x00010001
    s_mov_b32 s57, 0x00010001
    v_mov_b32 v23, 0xbf003f00
    v_mov_b32 v22, 0x3f003f00
    s_barrier
    s_nop 0
    ds_read_b128 v[224:227], v16 offset:0
    ds_read_b128 v[232:235], v16 offset:2048
    ds_read_b128 v[240:243], v16 offset:1024
    ds_read_b128 v[244:247], v16 offset:3072
    s_xor_b32 s46, s3, 4
    v_lshlrev_b32 v18, 7, v4
    v_lshl_add_u32 v18, v5, 3, v18
    v_add_u32 v18, 143360, v18
    ds_read_b64 v[24:25], v18
    ds_read_b64 v[26:27], v18 offset:2048
    v_lshlrev_b32_e64 v21, 6, v4
    v_lshl_add_u32 v21, v5, 4, v21
    s_mul_i32 s49, s46, 4128
    s_add_u32 s49, s49, 102400
    v_add_u32 v21, s49, v21
    v_and_b32 v6, 7, v4
    v_xor_b32 v6, v6, v5
    v_lshlrev_b32 v6, 4, v6
    v_lshl_add_u32 v6, v4, 7, v6
    s_lshl_b32 s49, s46, 12
    s_add_u32 s49, s49, 69632
    v_add_u32 v6, s49, v6
    v_xor_b32 v7, 64, v6
    v_xor_b32 v17, v1, v2
    v_lshlrev_b32_e64 v17, 4, v17
    v_lshl_add_u32 v17, v1, 7, v17
    v_add_u32_e64 v17, s49, v17
    v_xor_b32 v250, 0x380, v17
    v_sub_u32 v30, 0, v0
    v_and_b32 v30, 63, v30
    v_lshrrev_b32 v31, 3, v30
    v_and_b32 v30, 7, v30
    v_xor_b32 v30, v30, v31
    v_lshlrev_b32 v30, 4, v30
    v_lshl_add_u32 v30, v31, 7, v30
    v_cmp_eq_u32 vcc, 0, v0
    v_mov_b32 v31, 1024
    s_nop 0
    v_cndmask_b32 v31, v31, v0, vcc
    v_add3_u32 v30, v30, v31, s49
    v_xor_b32 v31, 1024, v30
    v_lshlrev_b32 v3, 4, v0
    s_mul_i32 s64, s45, 2176
    s_add_u32 s64, s64, 0x200000
    s_mul_i32 s49, s46, 278528
    s_sub_u32 s66, s64, s49
    s_add_u32 s64, s64, s49
    s_add_u32 s65, s64, 139264
    s_add_u32 s66, s66, 4456448
    s_sub_u32 s67, s66, 139264
    s_lshr_b32 s73, s45, 4
    s_add_u32 s73, s73, 128
    s_lshl_b32 s73, s73, 8
    s_and_b32 s74, s45, 15
    s_lshl_b32 s74, s74, 3
    s_add_u32 s73, s73, s74
    s_mov_b32 s58, 0x80008000
    s_mov_b32 s59, 0x80000000
    s_waitcnt lgkmcnt(0)
    s_mov_b32 s40, s24
    s_nop 0
    s_and_b32 s41, s25, 0xffff
    s_mov_b32 s42, 0x1000000
    s_mov_b32 s43, 0x20000
    v_xor_b32 v26, s58, v26
    v_xor_b32 v28, s58, v24
    v_xor_b32 v27, s58, v27
    v_xor_b32 v29, s58, v25
    v_cndmask_b32 v228, v232, v23, s[56:57]
    v_cndmask_b32 v156, v224, v22, s[56:57]
    v_xor_b32 v236, s58, v232
    v_xor_b32 v252, s58, v244
    v_cndmask_b32 v229, v233, v23, s[56:57]
    v_cndmask_b32 v157, v225, v22, s[56:57]
    v_xor_b32 v237, s58, v233
    v_xor_b32 v253, s58, v245
    v_cndmask_b32 v230, v234, v23, s[56:57]
    v_cndmask_b32 v158, v226, v22, s[56:57]
    v_xor_b32 v238, s58, v234
    v_xor_b32 v254, s58, v246
    v_cndmask_b32 v231, v235, v23, s[56:57]
    v_cndmask_b32 v159, v227, v22, s[56:57]
    v_xor_b32 v239, s58, v235
    v_xor_b32 v255, s58, v247
    s_barrier
H_b1_0:
    s_cbranch_execz H_b1_4
    ds_read_b64_tr_b16 v[32:33], v8 offset:0
    ds_read_b64_tr_b16 v[34:35], v8 offset:4096
    ds_read_b64_tr_b16 v[36:37], v9 offset:0
    ds_read_b64_tr_b16 v[38:39], v9 offset:4096
    ds_read_b64_tr_b16 v[40:41], v10 offset:0
    ds_read_b64_tr_b16 v[42:43], v10 offset:4096
    ds_read_b64_tr_b16 v[44:45], v11 offset:0
    ds_read_b64_tr_b16 v[46:47], v11 offset:4096
    ds_read_b64_tr_b16 v[48:49], v12 offset:0
    ds_read_b64_tr_b16 v[50:51], v12 offset:4096
    ds_read_b64_tr_b16 v[52:53], v13 offset:0
    ds_read_b64_tr_b16 v[54:55], v13 offset:4096
    ds_read_b64_tr_b16 v[56:57], v14 offset:0
    ds_read_b64_tr_b16 v[58:59], v14 offset:4096
    ds_read_b64_tr_b16 v[60:61], v15 offset:0
    ds_read_b64_tr_b16 v[62:63], v15 offset:4096
    s_waitcnt lgkmcnt(14)
    v_mfma_f32_16x16x32_bf16 v[64:67], v[32:35], v[156:159], 0
    v_mfma_f32_16x16x32_bf16 v[96:99], v[32:35], v[228:231], 0
    s_waitcnt lgkmcnt(12)
    v_mfma_f32_16x16x32_bf16 v[68:71], v[36:39], v[156:159], 0
    v_mfma_f32_16x16x32_bf16 v[100:103], v[36:39], v[228:231], 0
    s_waitcnt lgkmcnt(10)
    v_mfma_f32_16x16x32_bf16 v[72:75], v[40:43], v[156:159], 0
    v_mfma_f32_16x16x32_bf16 v[104:107], v[40:43], v[228:231], 0
    s_waitcnt lgkmcnt(8)
    v_mfma_f32_16x16x32_bf16 v[76:79], v[44:47], v[156:159], 0
    v_mfma_f32_16x16x32_bf16 v[108:111], v[44:47], v[228:231], 0
    s_waitcnt lgkmcnt(0)
    s_nop 0
    v_mfma_f32_16x16x32_bf16 v[80:83], v[48:51], v[156:159], 0
    v_cvt_pk_bf16_f32 v128, v64, v68
    v_cvt_pk_bf16_f32 v136, v65, v69
    v_mfma_f32_16x16x32_bf16 v[84:87], v[52:55], v[156:159], 0
    v_cvt_pk_bf16_f32 v144, v66, v70
    v_cvt_pk_bf16_f32 v152, v67, v71
    v_mfma_f32_16x16x32_bf16 v[88:91], v[56:59], v[156:159], 0
    v_cvt_pk_bf16_f32 v129, v72, v76
    v_cvt_pk_bf16_f32 v137, v73, v77
    v_mfma_f32_16x16x32_bf16 v[92:95], v[60:63], v[156:159], 0
    v_cvt_pk_bf16_f32 v145, v74, v78
    v_cvt_pk_bf16_f32 v153, v75, v79
    v_mfma_f32_16x16x32_bf16 v[112:115], v[48:51], v[228:231], 0
    v_cvt_pk_bf16_f32 v130, v80, v84
    v_cvt_pk_bf16_f32 v138, v81, v85
    v_mfma_f32_16x16x32_bf16 v[116:119], v[52:55], v[228:231], 0
    v_cvt_pk_bf16_f32 v146, v82, v86
    v_cvt_pk_bf16_f32 v154, v83, v87
    v_mfma_f32_16x16x32_bf16 v[120:123], v[56:59], v[228:231], 0
    v_cvt_pk_bf16_f32 v131, v88, v92
    v_cvt_pk_bf16_f32 v139, v89, v93
H_b1_1:
    s_cbranch_execz H_b1_ret
    s_nop 0
    v_mfma_f32_16x16x32_bf16 v[124:127], v[60:63], v[228:231], 0
    v_cvt_pk_bf16_f32 v147, v90, v94
    v_cvt_pk_bf16_f32 v155, v91, v95
    v_mfma_f32_16x16x32_bf16 v[64:67], v[224:227], v[128:131], 0
    v_cvt_pk_bf16_f32 v132, v96, v100
    v_cvt_pk_bf16_f32 v140, v97, v101
    v_mfma_f32_16x16x32_bf16 v[72:75], v[224:227], v[136:139], 0
    v_cvt_pk_bf16_f32 v148, v98, v102
    v_cvt_pk_bf16_f32 v156, v99, v103
    v_mfma_f32_16x16x32_bf16 v[80:83], v[224:227], v[144:147], 0
    v_cvt_pk_bf16_f32 v133, v104, v108
    v_cvt_pk_bf16_f32 v141, v105, v109
    v_mfma_f32_16x16x32_bf16 v[88:91], v[224:227], v[152:155], 0
    v_cvt_pk_bf16_f32 v149, v106, v110
    v_cvt_pk_bf16_f32 v157, v107, v111
    v_mfma_f32_16x16x32_bf16 v[68:71], v[232:235], v[128:131], 0
    v_cvt_pk_bf16_f32 v134, v112, v116
    v_cvt_pk_bf16_f32 v142, v113, v117
    v_mfma_f32_16x16x32_bf16 v[76:79], v[232:235], v[136:139], 0
    v_cvt_pk_bf16_f32 v150, v114, v118
    v_cvt_pk_bf16_f32 v158, v115, v119
    v_mfma_f32_16x16x32_bf16 v[84:87], v[232:235], v[144:147], 0
    v_cvt_pk_bf16_f32 v135, v120, v124
    v_cvt_pk_bf16_f32 v143, v121, v125
    v_mfma_f32_16x16x32_bf16 v[92:95], v[232:235], v[152:155], 0
    v_cvt_pk_bf16_f32 v151, v122, v126
    v_cvt_pk_bf16_f32 v159, v123, v127
    v_mfma_f32_16x16x32_bf16 v[64:67], v[236:239], v[132:135], v[64:67]
    v_mfma_f32_16x16x32_bf16 v[72:75], v[236:239], v[140:143], v[72:75]
    v_mfma_f32_16x16x32_bf16 v[80:83], v[236:239], v[148:151], v[80:83]
    v_mfma_f32_16x16x32_bf16 v[88:91], v[236:239], v[156:159], v[88:91]
    v_mfma_f32_16x16x32_bf16 v[96:99], v[240:243], v[128:131], 0
    v_mfma_f32_16x16x32_bf16 v[104:107], v[240:243], v[136:139], 0
    v_mfma_f32_16x16x32_bf16 v[112:115], v[240:243], v[144:147], 0
    v_mfma_f32_16x16x32_bf16 v[120:123], v[240:243], v[152:155], 0
    s_nop 0
    v_mul_f32 v32, v64, v160
    v_mfma_f32_16x16x32_bf16 v[68:71], v[224:227], v[132:135], v[68:71]
    v_mul_f32 v36, v72, v164
    v_mul_f32 v40, v80, v168
    v_mfma_f32_16x16x32_bf16 v[76:79], v[224:227], v[140:143], v[76:79]
    v_mul_f32 v44, v88, v172
    v_mul_f32 v33, v65, v161
    v_mfma_f32_16x16x32_bf16 v[84:87], v[224:227], v[148:151], v[84:87]
    v_mul_f32 v37, v73, v165
    v_mul_f32 v41, v81, v169
    v_mfma_f32_16x16x32_bf16 v[92:95], v[224:227], v[156:159], v[92:95]
    v_fma_f32 v32, -v68, v192, v32
    v_mul_f32_e64 v45, v89, v173
    v_mfma_f32_16x16x32_bf16 v[100:103], v[244:247], v[128:131], 0
    v_fma_f32 v36, -v76, v196, v36
    v_fma_f32 v33, -v69, v193, v33
    v_mfma_f32_16x16x32_bf16 v[108:111], v[244:247], v[136:139], 0
H_b1_2:
    s_cbranch_execz H_b1_ret
    s_nop 0
    v_fma_f32 v40, -v84, v200, v40
    v_fma_f32 v37, -v77, v197, v37
    v_mfma_f32_16x16x32_bf16 v[116:119], v[244:247], v[144:147], 0
    v_fma_f32 v44, -v92, v204, v44
    v_fma_f32 v41, -v85, v201, v41
    v_mfma_f32_16x16x32_bf16 v[124:127], v[244:247], v[152:155], 0
    v_fma_f32 v45, -v93, v205, v45
    v_mul_f32_e64 v68, v68, v160
    v_mfma_f32_16x16x32_bf16 v[96:99], v[252:255], v[132:135], v[96:99]
    v_mul_f32 v34, v66, v162
    v_mul_f32 v76, v76, v164
    v_mfma_f32_16x16x32_bf16 v[104:107], v[252:255], v[140:143], v[104:107]
    v_mul_f32 v38, v74, v166
    v_mul_f32 v84, v84, v168
    v_mfma_f32_16x16x32_bf16 v[112:115], v[252:255], v[148:151], v[112:115]
    v_mul_f32 v42, v82, v170
    v_mul_f32 v92, v92, v172
    v_mfma_f32_16x16x32_bf16 v[120:123], v[252:255], v[156:159], v[120:123]
    v_mul_f32 v46, v90, v174
    v_fmac_f32 v68, v64, v192
    v_mfma_f32_16x16x32_bf16 v[100:103], v[240:243], v[132:135], v[100:103]
    v_mul_f32_e64 v69, v69, v161
    v_fma_f32 v34, -v70, v194, v34
    v_mfma_f32_16x16x32_bf16 v[108:111], v[240:243], v[140:143], v[108:111]
    v_mul_f32 v35, v67, v163
    v_fmac_f32 v76, v72, v196
    v_mfma_f32_16x16x32_bf16 v[116:119], v[240:243], v[148:151], v[116:119]
    v_mul_f32_e64 v77, v77, v165
    v_fma_f32 v38, -v78, v198, v38
    v_mfma_f32_16x16x32_bf16 v[124:127], v[240:243], v[156:159], v[124:127]
    v_mul_f32 v39, v75, v167
    v_fmac_f32 v84, v80, v200
    v_mul_f32_e64 v85, v85, v169
    v_fma_f32 v42, -v86, v202, v42
    v_mul_f32 v43, v83, v171
    v_fmac_f32 v92, v88, v204
    v_mul_f32_e64 v93, v93, v173
    v_fma_f32 v46, -v94, v206, v46
    v_mul_f32 v47, v91, v175
    v_fmac_f32 v69, v65, v193
    v_fma_f32 v35, -v71, v195, v35
    v_fmac_f32_e64 v77, v73, v197
    v_fma_f32 v39, -v79, v199, v39
    v_fmac_f32_e64 v85, v81, v201
    v_fma_f32 v43, -v87, v203, v43
    v_fmac_f32_e64 v93, v89, v205
    v_fma_f32 v47, -v95, v207, v47
    v_pk_mul_f32 v[48:49], v[96:97], v[176:177]
    v_pk_mul_f32 v[52:53], v[104:105], v[180:181]
    v_pk_mul_f32 v[56:57], v[112:113], v[184:185]
    v_pk_mul_f32 v[60:61], v[120:121], v[188:189]
    v_mul_f32 v70, v70, v162
    v_mul_f32 v78, v78, v166
    v_mul_f32 v86, v86, v170
    v_mul_f32 v94, v94, v174
    v_cvt_pk_bf16_f32 v8, v32, v36
    v_cvt_pk_bf16_f32 v9, v40, v44
    v_cvt_pk_bf16_f32 v10, v68, v76
H_b1_3:
    s_cbranch_execz H_b1_ret
    s_nop 0
    v_cvt_pk_bf16_f32 v11, v84, v92
    v_pk_fma_f32 v[48:49], v[100:101], v[208:209], v[48:49] neg_lo:[1,0,0] neg_hi:[1,0,0]
    v_pk_fma_f32 v[52:53], v[108:109], v[212:213], v[52:53] neg_lo:[1,0,0] neg_hi:[1,0,0]
    v_pk_fma_f32 v[56:57], v[116:117], v[216:217], v[56:57] neg_lo:[1,0,0] neg_hi:[1,0,0]
    v_pk_fma_f32 v[60:61], v[124:125], v[220:221], v[60:61] neg_lo:[1,0,0] neg_hi:[1,0,0]
    v_fmac_f32 v70, v66, v194
    v_mul_f32 v71, v71, v163
    v_fmac_f32 v78, v74, v198
    v_mul_f32 v79, v79, v167
    v_fmac_f32 v86, v82, v202
    v_mul_f32 v87, v87, v171
    v_fmac_f32 v94, v90, v206
    v_mul_f32 v95, v95, v175
    v_cvt_pk_bf16_f32 v12, v33, v37
    v_cvt_pk_bf16_f32 v13, v41, v45
    v_cvt_pk_bf16_f32 v14, v69, v77
    v_cvt_pk_bf16_f32 v15, v85, v93
    ds_write_b128 v20, v[8:11] offset:0
    v_pk_mul_f32 v[50:51], v[98:99], v[178:179]
    v_pk_mul_f32 v[54:55], v[106:107], v[182:183]
    v_pk_mul_f32 v[58:59], v[114:115], v[186:187]
    v_pk_mul_f32 v[62:63], v[122:123], v[190:191]
    v_fmac_f32 v71, v67, v195
    v_fmac_f32 v79, v75, v199
    v_fmac_f32 v87, v83, v203
    v_fmac_f32 v95, v91, v207
    v_pk_mul_f32 v[100:101], v[100:101], v[176:177]
    v_pk_mul_f32 v[108:109], v[108:109], v[180:181]
    v_pk_mul_f32 v[116:117], v[116:117], v[184:185]
    v_pk_mul_f32 v[124:125], v[124:125], v[188:189]
    ds_write_b128 v20, v[12:15] offset:64
    v_cvt_pk_bf16_f32 v8, v34, v38
    v_cvt_pk_bf16_f32 v9, v42, v46
    v_cvt_pk_bf16_f32 v10, v70, v78
    v_cvt_pk_bf16_f32 v11, v86, v94
    v_pk_fma_f32 v[50:51], v[102:103], v[210:211], v[50:51] neg_lo:[1,0,0] neg_hi:[1,0,0]
    v_pk_fma_f32 v[54:55], v[110:111], v[214:215], v[54:55] neg_lo:[1,0,0] neg_hi:[1,0,0]
    v_pk_fma_f32 v[58:59], v[118:119], v[218:219], v[58:59] neg_lo:[1,0,0] neg_hi:[1,0,0]
    v_pk_fma_f32 v[62:63], v[126:127], v[222:223], v[62:63] neg_lo:[1,0,0] neg_hi:[1,0,0]
    v_pk_fma_f32 v[100:101], v[96:97], v[208:209], v[100:101]
    v_pk_fma_f32 v[108:109], v[104:105], v[212:213], v[108:109]
    v_pk_fma_f32 v[116:117], v[112:113], v[216:217], v[116:117]
    v_pk_fma_f32 v[124:125], v[120:121], v[220:221], v[124:125]
    v_cvt_pk_bf16_f32 v12, v35, v39
    v_cvt_pk_bf16_f32 v13, v43, v47
    v_cvt_pk_bf16_f32 v14, v71, v79
    v_cvt_pk_bf16_f32 v15, v87, v95
    ds_write_b128 v20, v[8:11] offset:128
    v_pk_mul_f32 v[102:103], v[102:103], v[178:179]
    v_pk_mul_f32 v[110:111], v[110:111], v[182:183]
H_b1_4:
    s_cbranch_execz H_b1_ret
    s_nop 0
    v_pk_mul_f32 v[118:119], v[118:119], v[186:187]
    v_pk_mul_f32 v[126:127], v[126:127], v[190:191]
    v_cvt_pk_bf16_f32 v128, v48, v52
    v_cvt_pk_bf16_f32 v129, v56, v60
    v_cvt_pk_bf16_f32 v130, v100, v108
    v_cvt_pk_bf16_f32 v131, v116, v124
    ds_write_b128 v20, v[12:15] offset:192
    v_pk_fma_f32 v[102:103], v[98:99], v[210:211], v[102:103]
    v_pk_fma_f32 v[110:111], v[106:107], v[214:215], v[110:111]
    v_pk_fma_f32 v[118:119], v[114:115], v[218:219], v[118:119]
    v_pk_fma_f32 v[126:127], v[122:123], v[222:223], v[126:127]
    v_cvt_pk_bf16_f32 v132, v49, v53
    v_cvt_pk_bf16_f32 v133, v57, v61
    v_cvt_pk_bf16_f32 v134, v101, v109
    v_cvt_pk_bf16_f32 v135, v117, v125
    ds_write_b128 v20, v[128:131] offset:1024
    v_cvt_pk_bf16_f32 v136, v50, v54
    v_cvt_pk_bf16_f32 v137, v58, v62
    v_cvt_pk_bf16_f32 v138, v102, v110
    v_cvt_pk_bf16_f32 v139, v118, v126
    ds_write_b128 v20, v[132:135] offset:1088
    v_cvt_pk_bf16_f32 v140, v51, v55
    v_cvt_pk_bf16_f32 v141, v59, v63
    v_cvt_pk_bf16_f32 v142, v103, v111
    v_cvt_pk_bf16_f32 v143, v119, v127
    ds_write_b128 v20, v[136:139] offset:1152
    ds_write_b128 v20, v[140:143] offset:1216
H_b2_0:
    s_cbranch_execz H_b2_ret
    v_mov_b32_e64 v22, 1
    s_mov_b64 exec, 1
    ds_add_u32 v19, v22 offset:28
    s_mov_b64 exec, -1
    s_mov_b32 s49, 0
LBx_watch:
    ds_read_b32 v22, v19 offset:28
    s_add_u32 s49, s49, 1
    s_waitcnt lgkmcnt(0)
    v_readfirstlane_b32 s51, v22
    s_nop 0
    s_cmp_ge_u32 s51, 4
    s_cbranch_scc1 LBx_seen
    s_cmp_lt_u32 s49, 0x80000
    s_cbranch_scc1 LBx_watch
    s_nop 0
LBx_seen:
    ds_read_b128 v[32:35], v21 offset:0
    ds_read_b128 v[36:39], v21 offset:1024
    ds_read_b128 v[40:43], v21 offset:2064
    ds_read_b128 v[44:47], v21 offset:3088
    s_waitcnt lgkmcnt(3)
    v_mfma_f32_16x16x32_bf16 v[64:67], v[32:35], v[24:27], 0
    v_mfma_f32_16x16x32_bf16 v[68:71], v[32:35], v[26:29], 0
    s_waitcnt lgkmcnt(2)
    v_mfma_f32_16x16x32_bf16 v[72:75], v[36:39], v[24:27], 0
    v_mfma_f32_16x16x32_bf16 v[76:79], v[36:39], v[26:29], 0
    s_waitcnt lgkmcnt(1)
    v_mfma_f32_16x16x32_bf16 v[80:83], v[40:43], v[24:27], 0
    v_mfma_f32_16x16x32_bf16 v[84:87], v[40:43], v[26:29], 0
    s_waitcnt lgkmcnt(0)
    v_mfma_f32_16x16x32_bf16 v[88:91], v[44:47], v[24:27], 0
    v_mfma_f32_16x16x32_bf16 v[92:95], v[44:47], v[26:29], 0
    s_nop 4
    s_nop 0
    v_cvt_pk_bf16_f32 v136, v80, v84
    v_cvt_pk_bf16_f32 v137, v81, v85
    v_cvt_pk_bf16_f32 v138, v82, v86
    v_cvt_pk_bf16_f32 v139, v83, v87
    ds_write_b128 v6, v[136:139] offset:2048
    v_cvt_pk_bf16_f32 v140, v88, v92
    v_cvt_pk_bf16_f32 v141, v89, v93
    v_cvt_pk_bf16_f32 v142, v90, v94
    v_cvt_pk_bf16_f32 v143, v91, v95
    ds_write_b128 v7, v[140:143] offset:2048
    ds_read_b128 v[168:171], v17 offset:2048
    ds_read_b128 v[172:175], v17 offset:3072
    ds_read_b128 v[184:187], v250 offset:3072
    ds_read_b32 v194, v30 offset:2048
    ds_read_b128 v[188:191], v250 offset:2048
    ds_read_b32 v195, v31 offset:2048
    v_cvt_pk_bf16_f32 v128, v64, v68
    v_cvt_pk_bf16_f32 v129, v65, v69
    v_cvt_pk_bf16_f32 v130, v66, v70
    v_cvt_pk_bf16_f32 v131, v67, v71
    ds_write_b128 v6, v[128:131] offset:0
    v_cvt_pk_bf16_f32 v132, v72, v76
    v_cvt_pk_bf16_f32 v133, v73, v77
    v_cvt_pk_bf16_f32 v134, v74, v78
    v_cvt_pk_bf16_f32 v135, v75, v79
    ds_write_b128 v7, v[132:135] offset:0
H_b2_1:
    s_cbranch_execz H_b2_ret
    s_nop 0
    ds_read_b128 v[160:163], v17 offset:0
    ds_read_b128 v[164:167], v17 offset:1024
    ds_read_b128 v[176:179], v250 offset:1024
    ds_read_b32 v192, v30 offset:0
    ds_read_b128 v[180:183], v250 offset:0
    ds_read_b32 v193, v31 offset:0
    s_waitcnt lgkmcnt(8)
    buffer_store_dwordx4 v[168:171], v3, s[40:43], s65 offen offset:0 sc1
    buffer_store_dwordx4 v[172:175], v3, s[40:43], s65 offen offset:1024 sc1
    v_xor_b32 v204, s59, v194
    v_xor_b32 v205, s59, v187
    v_xor_b32 v206, s59, v186
    v_xor_b32_e64 v207, s59, v185
    buffer_store_dwordx4 v[204:207], v3, s[40:43], s67 offen offset:0 sc1
    v_xor_b32 v208, s59, v195
    v_xor_b32 v209, s59, v191
    v_xor_b32 v210, s59, v190
    v_xor_b32 v211, s59, v189
    buffer_store_dwordx4 v[208:211], v3, s[40:43], s67 offen offset:1024 sc1
    s_waitcnt lgkmcnt(0)
    s_cmp_eq_u32 s46, 0
    s_cbranch_scc1 L_mix
    buffer_store_dwordx4 v[160:163], v3, s[40:43], s64 offen offset:0 sc1
    buffer_store_dwordx4 v[164:167], v3, s[40:43], s64 offen offset:1024 sc1
    v_xor_b32 v196, s59, v192
    v_xor_b32 v197, s59, v179
    v_xor_b32 v198, s59, v178
    v_xor_b32_e64 v199, s59, v177
    buffer_store_dwordx4 v[196:199], v3, s[40:43], s66 offen offset:0 sc1
    v_xor_b32 v200, s59, v193
    v_xor_b32 v201, s59, v183
    v_xor_b32 v202, s59, v182
    v_xor_b32 v203, s59, v181
    buffer_store_dwordx4 v[200:203], v3, s[40:43], s66 offen offset:1024 sc1
L_sig:
    s_mov_b32 s49, 0
LBt_watch:
    ds_read_b32 v23, v19 offset:4
    s_add_u32 s49, s49, 1
    s_waitcnt lgkmcnt(0)
    v_readfirstlane_b32 s51, v23
    s_nop 0
    s_cmp_ge_u32 s51, 1
    s_cbranch_scc1 LBt_seen
    s_cmp_lt_u32 s49, 0x80000
    s_cbranch_scc1 LBt_watch
LBt_seen:
    ds_read_b32 v22, v19
    v_mov_b32 v21, 1
    v_lshlrev_b32 v16, 10, v0
    s_add_u32 s73, s73, 0x700000
    s_mov_b64 exec, 1
    s_waitcnt vmcnt(0)
    ds_add_rtn_u32 v20, v19, v21 offset:8
    s_waitcnt lgkmcnt(0)
    v_readfirstlane_b32 s49, v20
    s_nop 0
    s_cmp_lg_u32 s49, 7
    s_cbranch_scc1 LB_nosig
    s_nop 0
    s_mov_b64 exec, 0xff
    buffer_store_dwordx2 v[22:23], v16, s[40:43], s73 offen sc1
    ds_add_u32 v19, v21 offset:8
LB_nosig:
    s_mov_b64 exec, -1
    s_cmp_lt_u32 s3, 4
    s_cbranch_scc1 L_F
    s_lshl_b32 s53, s27, 2
    s_add_u32 s53, s53, s3
    s_sub_u32 s53, s53, 4
    v_lshlrev_b32 v21, 7, v0
    s_mov_b32 s49, 0
LBd_watch:
    ds_read_b32 v23, v19 offset:8
    s_add_u32 s49, s49, 1
    s_waitcnt lgkmcnt(0)
    v_readfirstlane_b32 s51, v23
    s_nop 0
    s_cmp_ge_u32 s51, 9
    s_cbranch_scc1 LBd_seen
    s_sleep 4
    s_cmp_lt_u32 s49, 0x80000
    s_cbranch_scc1 LBd_watch
LBd_seen:
    s_mov_b32 s40, s24
    s_nop 0
    s_and_b32 s41, s25, 0xffff
    s_mov_b32 s42, 0x1000000
    s_mov_b32 s43, 0x20000
    s_lshl_b32 s50, s26, 5
    s_add_u32 s50, s50, s53
    s_lshl_b32 s50, s50, 13
    s_nop 0
    s_add_u32 s50, s50, 0xa00000
    buffer_load_dword v248, v21, s[40:43], s50 offen
    s_mul_i32 s50, s26, 768
    s_add_u32 s50, s50, 0x700000
    s_mov_b64 exec, 0x3f
    buffer_load_dword v248, v21, s[40:43], s50 offen sc1
    s_mov_b64 exec, -1
    s_endpgm
L_mix:
H_b2_2:
    s_cbranch_execz H_b2_ret
    s_mov_b32 s58, 0xffff0000
    s_add_u32 s66, s64, 2228224
    v_lshlrev_b32 v220, 16, v160
    v_lshlrev_b32 v221, 16, v192
    v_and_b32 v222, s58, v160
    v_and_b32 v223, s58, v192
    v_add_f32 v224, v220, v221
    v_sub_f32 v225, v222, v223
    v_add_f32 v226, v222, v223
    v_sub_f32 v227, v220, v221
    v_cvt_pk_bf16_f32 v196, v224, v225
    v_cvt_pk_bf16_f32 v212, -v226, v227
    v_lshlrev_b32 v220, 16, v161
    v_lshlrev_b32 v221, 16, v179
    v_and_b32 v222, s58, v161
    v_and_b32 v223, s58, v179
    v_add_f32 v224, v220, v221
    v_sub_f32 v225, v222, v223
    v_add_f32 v226, v222, v223
    v_sub_f32 v227, v220, v221
    v_cvt_pk_bf16_f32 v197, v224, v225
    v_cvt_pk_bf16_f32 v213, -v226, v227
    v_lshlrev_b32 v220, 16, v162
    v_lshlrev_b32 v221, 16, v178
    v_and_b32 v222, s58, v162
    v_and_b32 v223, s58, v178
    v_add_f32 v224, v220, v221
    v_sub_f32 v225, v222, v223
    v_add_f32 v226, v222, v223
    v_sub_f32 v227, v220, v221
    v_cvt_pk_bf16_f32 v198, v224, v225
    v_cvt_pk_bf16_f32 v214, -v226, v227
    v_lshlrev_b32 v220, 16, v163
    v_lshlrev_b32 v221, 16, v177
    v_and_b32 v222, s58, v163
    v_and_b32 v223, s58, v177
    v_add_f32 v224, v220, v221
    v_sub_f32 v225, v222, v223
    v_add_f32 v226, v222, v223
    v_sub_f32 v227, v220, v221
    v_cvt_pk_bf16_f32 v199, v224, v225
    v_cvt_pk_bf16_f32 v215, -v226, v227
    buffer_store_dwordx4 v[196:199], v3, s[40:43], s64 offen offset:0 sc1
    buffer_store_dwordx4 v[212:215], v3, s[40:43], s66 offen offset:0 sc1
    v_lshlrev_b32 v220, 16, v164
    v_lshlrev_b32 v221, 16, v193
    v_and_b32 v222, s58, v164
    v_and_b32 v223, s58, v193
    v_add_f32 v224, v220, v221
    v_sub_f32 v225, v222, v223
    v_add_f32 v226, v222, v223
    v_sub_f32 v227, v220, v221
    v_cvt_pk_bf16_f32 v200, v224, v225
    v_cvt_pk_bf16_f32 v216, -v226, v227
    v_lshlrev_b32 v220, 16, v165
    v_lshlrev_b32 v221, 16, v183
    v_and_b32 v222, s58, v165
    v_and_b32 v223, s58, v183
    v_add_f32 v224, v220, v221
    v_sub_f32 v225, v222, v223
    v_add_f32 v226, v222, v223
    v_sub_f32 v227, v220, v221
    v_cvt_pk_bf16_f32 v201, v224, v225
    v_cvt_pk_bf16_f32 v217, -v226, v227
    v_lshlrev_b32 v220, 16, v166
    v_lshlrev_b32 v221, 16, v182
    v_and_b32 v222, s58, v166
    v_and_b32 v223, s58, v182
    v_add_f32 v224, v220, v221
    v_sub_f32 v225, v222, v223
    v_add_f32 v226, v222, v223
    v_sub_f32 v227, v220, v221
    v_cvt_pk_bf16_f32 v202, v224, v225
    v_cvt_pk_bf16_f32 v218, -v226, v227
    v_lshlrev_b32 v220, 16, v167
    v_lshlrev_b32 v221, 16, v181
    v_and_b32 v222, s58, v167
    v_and_b32 v223, s58, v181
H_b2_3:
    s_cbranch_execz H_b2_ret
    v_add_f32 v224, v220, v221
    v_sub_f32 v225, v222, v223
    v_add_f32 v226, v222, v223
    v_sub_f32_e64 v227, v220, v221
    v_cvt_pk_bf16_f32 v203, v224, v225
    v_cvt_pk_bf16_f32 v219, -v226, v227
    buffer_store_dwordx4 v[200:203], v3, s[40:43], s64 offen offset:1024 sc1
    buffer_store_dwordx4 v[216:219], v3, s[40:43], s66 offen offset:1024 sc1
    s_branch L_sig
L_F:
H_f_0:
    s_cbranch_execz H_f_4
    v_readfirstlane_b32 s94, v22
    v_readfirstlane_b32 s95, v23
    v_xor_b32 v5, 32, v8
    v_xor_b32 v6, 64, v8
    v_xor_b32 v7, 96, v8
    s_mov_b32 s49, 0
LFs_watch:
    ds_read_b32 v20, v19 offset:8
    s_add_u32 s49, s49, 1
    s_waitcnt lgkmcnt(0)
    v_readfirstlane_b32 s51, v20
    s_nop 0
    s_cmp_ge_u32 s51, 8
    s_cbranch_scc1 LFs_seen
    s_cmp_lt_u32 s49, 0x80000
    s_cbranch_scc1 LFs_watch
LFs_seen:
    ds_read_b64 v[24:25], v8 offset:0
    ds_read_b64 v[26:27], v8 offset:8192
    ds_read_b64 v[28:29], v5 offset:0
    ds_read_b64 v[30:31], v5 offset:8192
    ds_read_b64 v[32:33], v6 offset:0
    ds_read_b64 v[34:35], v6 offset:8192
    ds_read_b64 v[36:37], v7 offset:0
    ds_read_b64 v[38:39], v7 offset:8192
    ds_read_b64 v[40:41], v8 offset:2048
    ds_read_b64 v[42:43], v8 offset:10240
    ds_read_b64 v[44:45], v5 offset:2048
    ds_read_b64 v[46:47], v5 offset:10240
    ds_read_b64 v[48:49], v6 offset:2048
    ds_read_b64 v[50:51], v6 offset:10240
    ds_read_b64 v[52:53], v7 offset:2048
    ds_read_b64 v[54:55], v7 offset:10240
    ds_read_b64 v[56:57], v8 offset:4096
    ds_read_b64 v[58:59], v8 offset:12288
    ds_read_b64 v[60:61], v5 offset:4096
    ds_read_b64 v[62:63], v5 offset:12288
    ds_read_b64 v[64:65], v6 offset:4096
    ds_read_b64 v[66:67], v6 offset:12288
    ds_read_b64 v[68:69], v7 offset:4096
    ds_read_b64 v[70:71], v7 offset:12288
    ds_read_b64 v[72:73], v8 offset:6144
    ds_read_b64 v[74:75], v8 offset:14336
    ds_read_b64 v[76:77], v5 offset:6144
    ds_read_b64 v[78:79], v5 offset:14336
    ds_read_b64 v[80:81], v6 offset:6144
    ds_read_b64 v[82:83], v6 offset:14336
    ds_read_b64 v[84:85], v7 offset:6144
    ds_read_b64 v[86:87], v7 offset:14336
    s_mov_b32 s88, s20
    s_nop 0
    s_and_b32 s89, s21, 0xffff
    s_mov_b32 s90, 0x400000
    s_mov_b32 s91, 0x20000
    s_waitcnt lgkmcnt(14)
    s_nop 0
    v_perm_b32 v88, v26, v24, s56
    v_perm_b32 v89, v26, v24, s57
    v_perm_b32 v90, v27, v25, s56
    v_perm_b32 v91, v27, v25, s57
H_f_1:
    s_cbranch_execz H_f_5
    s_nop 0
    v_perm_b32 v92, v30, v28, s56
    v_perm_b32 v93, v30, v28, s57
    v_perm_b32 v94, v31, v29, s56
    v_perm_b32 v95, v31, v29, s57
    v_perm_b32 v96, v34, v32, s56
    v_perm_b32 v97, v34, v32, s57
    v_perm_b32 v98, v35, v33, s56
    v_perm_b32 v99, v35, v33, s57
    v_perm_b32 v100, v38, v36, s56
    v_perm_b32 v101, v38, v36, s57
    v_perm_b32 v102, v39, v37, s56
    v_perm_b32 v103, v39, v37, s57
    s_waitcnt lgkmcnt(14)
    s_nop 0
    v_perm_b32 v104, v42, v40, s56
    v_perm_b32 v105, v42, v40, s57
    v_perm_b32 v106, v43, v41, s56
    v_perm_b32 v107, v43, v41, s57
    v_perm_b32 v108, v46, v44, s56
    v_perm_b32 v109, v46, v44, s57
    v_perm_b32 v110, v47, v45, s56
    v_perm_b32 v111, v47, v45, s57
    v_perm_b32 v112, v50, v48, s56
    v_perm_b32 v113, v50, v48, s57
    v_perm_b32 v114, v51, v49, s56
    v_perm_b32 v115, v51, v49, s57
    v_perm_b32 v116, v54, v52, s56
    v_perm_b32 v117, v54, v52, s57
    v_perm_b32 v118, v55, v53, s56
    v_perm_b32 v119, v55, v53, s57
    s_waitcnt lgkmcnt(8)
    s_nop 0
    v_perm_b32 v120, v58, v56, s56
    v_perm_b32 v121, v58, v56, s57
    v_perm_b32 v122, v59, v57, s56
    v_perm_b32 v123, v59, v57, s57
    v_perm_b32 v124, v62, v60, s56
    v_perm_b32 v125, v62, v60, s57
    v_perm_b32 v126, v63, v61, s56
    v_perm_b32 v127, v63, v61, s57
    v_perm_b32 v128, v66, v64, s56
    v_perm_b32 v129, v66, v64, s57
    v_perm_b32 v130, v67, v65, s56
    v_perm_b32 v131, v67, v65, s57
    v_perm_b32 v132, v70, v68, s56
    v_perm_b32 v133, v70, v68, s57
    v_perm_b32 v134, v71, v69, s56
    v_perm_b32 v135, v71, v69, s57
    s_waitcnt lgkmcnt(0)
    v_perm_b32 v136, v74, v72, s56
    v_perm_b32 v137, v74, v72, s57
H_f_2:
    s_cbranch_execz H_f_6
    v_perm_b32 v138, v75, v73, s56
    v_perm_b32 v139, v75, v73, s57
    v_perm_b32 v140, v78, v76, s56
    v_perm_b32 v141, v78, v76, s57
    v_perm_b32 v142, v79, v77, s56
    v_perm_b32 v143, v79, v77, s57
    v_perm_b32 v144, v82, v80, s56
    v_perm_b32 v145, v82, v80, s57
    v_perm_b32 v146, v83, v81, s56
    v_perm_b32 v147, v83, v81, s57
    v_perm_b32 v148, v86, v84, s56
    v_perm_b32 v149, v86, v84, s57
    v_perm_b32 v150, v87, v85, s56
    v_perm_b32 v151, v87, v85, s57
    s_cmp_lg_u32 s3, 1
    s_cbranch_scc1 LF_follow
    s_mov_b32 s49, 0
    s_mov_b64 exec, -1
LF_poll:
    buffer_load_dwordx2 v[20:21], v18, s[40:43], 0 offen sc1
    s_waitcnt vmcnt(0)
    v_cmp_eq_u64 vcc, s[94:95], v[20:21]
    s_nop 0
    s_cmp_eq_u64 vcc, exec
    s_cbranch_scc1 LF_pdone
    s_add_u32 s49, s49, 1
    s_cmp_lt_u32 s49, 0x8000
    s_cbranch_scc1 LF_poll
LF_pdone:
    s_mov_b64 exec, -1
    ds_write_b32 v19, v19 offset:16
    s_branch LF_seen
LF_follow:
    s_mov_b32 s49, 0
LF_watch:
    ds_read_b32 v20, v19 offset:16
    s_add_u32 s49, s49, 1
    s_waitcnt lgkmcnt(0)
    v_readfirstlane_b32 s51, v20
    s_nop 0
    s_cmp_ge_u32 s51, 1
    s_cbranch_scc1 LF_seen
    s_cmp_lt_u32 s49, 0x80000
    s_cbranch_scc1 LF_watch
LF_seen:
    s_mov_b32 s54, 0
    buffer_load_dwordx4 v[24:27], v10, s[40:43], s54 offen sc1
    s_mov_b32 s54, 2176
    buffer_load_dwordx4 v[28:31], v10, s[40:43], s54 offen sc1
    s_mov_b32 s54, 4352
    buffer_load_dwordx4 v[32:35], v10, s[40:43], s54 offen sc1
    s_mov_b32 s54, 6528
    buffer_load_dwordx4 v[36:39], v10, s[40:43], s54 offen sc1
    s_mov_b32 s54, 34816
    buffer_load_dwordx4 v[40:43], v10, s[40:43], s54 offen sc1
    s_mov_b32 s54, 36992
    buffer_load_dwordx4 v[44:47], v10, s[40:43], s54 offen sc1
    s_mov_b32 s54, 39168
    buffer_load_dwordx4 v[48:51], v10, s[40:43], s54 offen sc1
    s_mov_b32 s54, 41344
    buffer_load_dwordx4 v[52:55], v10, s[40:43], s54 offen sc1
    s_mov_b32 s54, 69632
    buffer_load_dwordx4 v[56:59], v10, s[40:43], s54 offen sc1
    s_mov_b32 s54, 71808
    buffer_load_dwordx4 v[60:63], v10, s[40:43], s54 offen sc1
    s_mov_b32 s54, 73984
    buffer_load_dwordx4 v[64:67], v10, s[40:43], s54 offen sc1
    s_mov_b32 s54, 76160
    buffer_load_dwordx4 v[68:71], v10, s[40:43], s54 offen sc1
    s_mov_b32 s54, 104448
    buffer_load_dwordx4 v[72:75], v10, s[40:43], s54 offen sc1
H_f_3:
    s_cbranch_execz H_f_ret
    s_nop 0
    s_mov_b32 s54, 106624
    buffer_load_dwordx4 v[76:79], v10, s[40:43], s54 offen sc1
    s_mov_b32 s54, 108800
    buffer_load_dwordx4 v[80:83], v10, s[40:43], s54 offen sc1
    s_mov_b32 s54, 110976
    buffer_load_dwordx4 v[84:87], v10, s[40:43], s54 offen sc1
    s_waitcnt vmcnt(12)
    v_mov_b32 v216, v24
    v_mov_b32 v217, v28
    v_mov_b32 v218, v32
    v_mov_b32 v219, v36
    v_mov_b32 v220, v25
    v_mov_b32 v221, v29
    v_mov_b32 v222, v33
    v_mov_b32 v223, v37
    v_mov_b32 v224, v26
    v_mov_b32 v225, v30
    v_mov_b32 v226, v34
    v_mov_b32 v227, v38
    v_mov_b32 v228, v27
    v_mov_b32 v229, v31
    v_mov_b32 v230, v35
    v_mov_b32_e64 v231, v39
    v_mfma_f32_16x16x32_bf16 v[152:155], v[216:219], v[88:91], 0
    v_mfma_f32_16x16x32_bf16 v[168:171], v[216:219], v[104:107], 0
    v_mfma_f32_16x16x32_bf16 v[184:187], v[216:219], v[120:123], 0
    v_mfma_f32_16x16x32_bf16 v[200:203], v[216:219], v[136:139], 0
    v_mfma_f32_16x16x32_bf16 v[156:159], v[220:223], v[88:91], 0
    v_mfma_f32_16x16x32_bf16 v[172:175], v[220:223], v[104:107], 0
    v_mfma_f32_16x16x32_bf16 v[188:191], v[220:223], v[120:123], 0
    v_mfma_f32_16x16x32_bf16 v[204:207], v[220:223], v[136:139], 0
    s_waitcnt vmcnt(8)
    v_mfma_f32_16x16x32_bf16 v[160:163], v[224:227], v[88:91], 0
    v_mov_b32 v232, v40
    v_mov_b32_e64 v233, v44
    v_mfma_f32_16x16x32_bf16 v[176:179], v[224:227], v[104:107], 0
    v_mov_b32 v234, v48
    v_mov_b32 v235, v52
    v_mfma_f32_16x16x32_bf16 v[192:195], v[224:227], v[120:123], 0
    v_mov_b32 v236, v41
    v_mov_b32 v237, v45
    v_mfma_f32_16x16x32_bf16 v[208:211], v[224:227], v[136:139], 0
    v_mov_b32 v238, v49
    v_mov_b32 v239, v53
    v_mfma_f32_16x16x32_bf16 v[164:167], v[228:231], v[88:91], 0
    v_mov_b32 v240, v42
    v_mov_b32 v241, v46
    v_mfma_f32_16x16x32_bf16 v[180:183], v[228:231], v[104:107], 0
    v_mov_b32 v242, v50
    v_mov_b32 v243, v54
    v_mfma_f32_16x16x32_bf16 v[196:199], v[228:231], v[120:123], 0
    v_mov_b32 v244, v43
    v_mov_b32 v245, v47
    v_mfma_f32_16x16x32_bf16 v[212:215], v[228:231], v[136:139], 0
    v_mov_b32 v246, v51
    v_mov_b32 v247, v55
    v_mfma_f32_16x16x32_bf16 v[152:155], v[232:235], v[92:95], v[152:155]
    v_mfma_f32_16x16x32_bf16 v[168:171], v[232:235], v[108:111], v[168:171]
    v_mfma_f32_16x16x32_bf16 v[184:187], v[232:235], v[124:127], v[184:187]
    v_mfma_f32_16x16x32_bf16 v[200:203], v[232:235], v[140:143], v[200:203]
    v_mfma_f32_16x16x32_bf16 v[156:159], v[236:239], v[92:95], v[156:159]
    v_mfma_f32_16x16x32_bf16 v[172:175], v[236:239], v[108:111], v[172:175]
    v_mfma_f32_16x16x32_bf16 v[188:191], v[236:239], v[124:127], v[188:191]
    v_mfma_f32_16x16x32_bf16 v[204:207], v[236:239], v[140:143], v[204:207]
    s_waitcnt vmcnt(4)
    v_mfma_f32_16x16x32_bf16 v[160:163], v[240:243], v[92:95], v[160:163]
    v_mov_b32 v216, v56
H_f_4:
    s_cbranch_execz H_f_ret
    v_mov_b32 v217, v60
    v_mfma_f32_16x16x32_bf16 v[176:179], v[240:243], v[108:111], v[176:179]
    v_mov_b32 v218, v64
    v_mov_b32 v219, v68
    v_mfma_f32_16x16x32_bf16 v[192:195], v[240:243], v[124:127], v[192:195]
    v_mov_b32 v220, v57
    v_mov_b32 v221, v61
    v_mfma_f32_16x16x32_bf16 v[208:211], v[240:243], v[140:143], v[208:211]
    v_mov_b32 v222, v65
    v_mov_b32 v223, v69
    v_mfma_f32_16x16x32_bf16 v[164:167], v[244:247], v[92:95], v[164:167]
    v_mov_b32 v224, v58
    v_mov_b32 v225, v62
    v_mfma_f32_16x16x32_bf16 v[180:183], v[244:247], v[108:111], v[180:183]
    v_mov_b32 v226, v66
    v_mov_b32 v227, v70
    v_mfma_f32_16x16x32_bf16 v[196:199], v[244:247], v[124:127], v[196:199]
    v_mov_b32 v228, v59
    v_mov_b32 v229, v63
    v_mfma_f32_16x16x32_bf16 v[212:215], v[244:247], v[140:143], v[212:215]
    v_mov_b32 v230, v67
    v_mov_b32 v231, v71
    v_mfma_f32_16x16x32_bf16 v[152:155], v[216:219], v[96:99], v[152:155]
    v_mfma_f32_16x16x32_bf16 v[168:171], v[216:219], v[112:115], v[168:171]
    v_mfma_f32_16x16x32_bf16 v[184:187], v[216:219], v[128:131], v[184:187]
    v_mfma_f32_16x16x32_bf16 v[200:203], v[216:219], v[144:147], v[200:203]
    v_mfma_f32_16x16x32_bf16 v[156:159], v[220:223], v[96:99], v[156:159]
    v_mfma_f32_16x16x32_bf16 v[172:175], v[220:223], v[112:115], v[172:175]
    v_mfma_f32_16x16x32_bf16 v[188:191], v[220:223], v[128:131], v[188:191]
    v_mfma_f32_16x16x32_bf16 v[204:207], v[220:223], v[144:147], v[204:207]
    s_waitcnt vmcnt(0)
    v_mfma_f32_16x16x32_bf16 v[160:163], v[224:227], v[96:99], v[160:163]
    v_mov_b32 v232, v72
    v_mov_b32_e64 v233, v76
    v_mfma_f32_16x16x32_bf16 v[176:179], v[224:227], v[112:115], v[176:179]
    v_mov_b32 v234, v80
    v_mov_b32 v235, v84
    v_mfma_f32_16x16x32_bf16 v[192:195], v[224:227], v[128:131], v[192:195]
    v_mov_b32 v236, v73
    v_mov_b32 v237, v77
    v_mfma_f32_16x16x32_bf16 v[208:211], v[224:227], v[144:147], v[208:211]
    v_mov_b32 v238, v81
    v_mov_b32 v239, v85
    v_mfma_f32_16x16x32_bf16 v[164:167], v[228:231], v[96:99], v[164:167]
    v_mov_b32 v240, v74
    v_mov_b32 v241, v78
    v_mfma_f32_16x16x32_bf16 v[180:183], v[228:231], v[112:115], v[180:183]
    v_mov_b32 v242, v82
    v_mov_b32 v243, v86
    v_mfma_f32_16x16x32_bf16 v[196:199], v[228:231], v[128:131], v[196:199]
    v_mov_b32 v244, v75
    v_mov_b32 v245, v79
    v_mfma_f32_16x16x32_bf16 v[212:215], v[228:231], v[144:147], v[212:215]
    v_mov_b32 v246, v83
    v_mov_b32 v247, v87
    v_mfma_f32_16x16x32_bf16 v[152:155], v[232:235], v[100:103], v[152:155]
    v_mfma_f32_16x16x32_bf16 v[156:159], v[236:239], v[100:103], v[156:159]
    v_mfma_f32_16x16x32_bf16 v[160:163], v[240:243], v[100:103], v[160:163]
    v_mfma_f32_16x16x32_bf16 v[164:167], v[244:247], v[100:103], v[164:167]
    v_mfma_f32_16x16x32_bf16 v[168:171], v[232:235], v[116:119], v[168:171]
    v_mfma_f32_16x16x32_bf16 v[172:175], v[236:239], v[116:119], v[172:175]
    v_mfma_f32_16x16x32_bf16 v[176:179], v[240:243], v[116:119], v[176:179]
    v_mfma_f32_16x16x32_bf16 v[180:183], v[244:247], v[116:119], v[180:183]
    v_mfma_f32_16x16x32_bf16 v[184:187], v[232:235], v[132:135], v[184:187]
H_f_5:
    s_cbranch_execz H_f_ret
    s_nop 0
    v_mfma_f32_16x16x32_bf16 v[188:191], v[236:239], v[132:135], v[188:191]
    v_mfma_f32_16x16x32_bf16 v[192:195], v[240:243], v[132:135], v[192:195]
    v_mfma_f32_16x16x32_bf16 v[196:199], v[244:247], v[132:135], v[196:199]
    v_mfma_f32_16x16x32_bf16 v[200:203], v[232:235], v[148:151], v[200:203]
    v_mfma_f32_16x16x32_bf16 v[204:207], v[236:239], v[148:151], v[204:207]
    v_mfma_f32_16x16x32_bf16 v[208:211], v[240:243], v[148:151], v[208:211]
    v_mfma_f32_16x16x32_bf16 v[212:215], v[244:247], v[148:151], v[212:215]
    v_cvt_pk_bf16_f32 v24, v152, v156
    v_cvt_pk_bf16_f32 v25, v160, v164
    v_cvt_pk_bf16_f32 v26, v153, v157
    v_cvt_pk_bf16_f32 v27, v161, v165
    v_cvt_pk_bf16_f32 v28, v154, v158
    v_cvt_pk_bf16_f32 v29, v162, v166
    v_cvt_pk_bf16_f32 v30, v155, v159
    v_cvt_pk_bf16_f32 v31, v163, v167
    ds_write_b128 v14, v[24:27] offset:0
    ds_write_b128 v15, v[28:31] offset:0
    ds_read_b128 v[88:91], v11 offset:0
    ds_read_b128 v[92:95], v11 offset:1024
    v_cvt_pk_bf16_f32 v32, v168, v172
    v_cvt_pk_bf16_f32 v33, v176, v180
    v_cvt_pk_bf16_f32 v34, v169, v173
    v_cvt_pk_bf16_f32 v35, v177, v181
    v_cvt_pk_bf16_f32 v36, v170, v174
    v_cvt_pk_bf16_f32 v37, v178, v182
    v_cvt_pk_bf16_f32 v38, v171, v175
    v_cvt_pk_bf16_f32 v39, v179, v183
    ds_write_b128 v14, v[32:35] offset:2048
    ds_write_b128 v15, v[36:39] offset:2048
    ds_read_b128 v[96:99], v11 offset:2048
    ds_read_b128 v[100:103], v11 offset:3072
    s_waitcnt lgkmcnt(4)
    s_mov_b32 s54, 0
    buffer_store_dwordx4 v[88:91], v13, s[88:91], s54 offen sc1
    s_mov_b32 s54, 524288
    buffer_store_dwordx4 v[92:95], v13, s[88:91], s54 offen sc1
    v_cvt_pk_bf16_f32 v40, v184, v188
    v_cvt_pk_bf16_f32 v41, v192, v196
    v_cvt_pk_bf16_f32 v42, v185, v189
    v_cvt_pk_bf16_f32 v43, v193, v197
    v_cvt_pk_bf16_f32 v44, v186, v190
    v_cvt_pk_bf16_f32 v45, v194, v198
    v_cvt_pk_bf16_f32 v46, v187, v191
    v_cvt_pk_bf16_f32 v47, v195, v199
    ds_write_b128 v14, v[40:43] offset:4096
    ds_write_b128 v15, v[44:47] offset:4096
    ds_read_b128 v[104:107], v11 offset:4096
    ds_read_b128 v[108:111], v11 offset:5120
    s_waitcnt lgkmcnt(4)
    s_mov_b32 s54, 1048576
H_f_6:
    s_cbranch_execz H_f_ret
    buffer_store_dwordx4 v[96:99], v13, s[88:91], s54 offen sc1
    s_mov_b32 s54, 1572864
    buffer_store_dwordx4 v[100:103], v13, s[88:91], s54 offen sc1
    v_cvt_pk_bf16_f32 v48, v200, v204
    v_cvt_pk_bf16_f32 v49, v208, v212
    v_cvt_pk_bf16_f32 v50, v201, v205
    v_cvt_pk_bf16_f32 v51, v209, v213
    v_cvt_pk_bf16_f32 v52, v202, v206
    v_cvt_pk_bf16_f32 v53, v210, v214
    v_cvt_pk_bf16_f32 v54, v203, v207
    v_cvt_pk_bf16_f32 v55, v211, v215
    ds_write_b128 v14, v[48:51] offset:6144
    ds_write_b128 v15, v[52:55] offset:6144
    ds_read_b128 v[112:115], v11 offset:6144
    ds_read_b128 v[116:119], v11 offset:7168
    s_waitcnt lgkmcnt(4)
    s_nop 0
    s_mov_b32 s54, 2097152
    buffer_store_dwordx4 v[104:107], v13, s[88:91], s54 offen sc1
    s_mov_b32 s54, 2621440
    buffer_store_dwordx4 v[108:111], v13, s[88:91], s54 offen sc1
    s_waitcnt lgkmcnt(0)
    s_nop 0
    s_mov_b32 s54, 3145728
    buffer_store_dwordx4 v[112:115], v13, s[88:91], s54 offen sc1
    s_mov_b32 s54, 3670016
    buffer_store_dwordx4 v[116:119], v13, s[88:91], s54 offen sc1
L_end:
    s_endpgm
.section .rodata,"a"
.p2align 6
.amdhsa_kernel concat_heads__sliding_local_dilated__spectral_fnet__prompt_kernel
  .amdhsa_next_free_vgpr 256
  .amdhsa_next_free_sgpr 102
  .amdhsa_accum_offset 256
  .amdhsa_group_segment_fixed_size 0
  .amdhsa_kernarg_size 88
  .amdhsa_user_sgpr_count 2
  .amdhsa_user_sgpr_kernarg_segment_ptr 1
  .amdhsa_system_sgpr_workgroup_id_x 1
.end_amdhsa_kernel
```
